```python
import torch

def _softmax(x, axis=-1):
    return torch.softmax(x, dim=axis)
def _gelu(x):
    return torch.nn.functional.gelu(x, approximate="tanh")
def _silu(x):
    return torch.nn.functional.silu(x)
def _sigmoid(x):
    return torch.sigmoid(x)
def _layernorm(x, axis=-1, eps=1e-5):
    m = x.mean(dim=axis, keepdim=True)
    v = x.var(dim=axis, keepdim=True, unbiased=False)
    return (x - m) / torch.sqrt(v + eps)
def _scatter_add(tgt, idx, src, axis=0):
    return tgt.clone().index_add_(axis, idx, src)
def _segment_sum(src, seg, n):
    out = torch.zeros((n,) + src.shape[1:], dtype=src.dtype)
    return out.index_add_(0, seg, src)
def _pad(x, pw):
    flat = tuple(v for pair in reversed(pw) for v in pair)
    return torch.nn.functional.pad(x, flat)

kernel_name = 'interleave_layers__ssm_conv_s4__dense_activation_squared_relu__prompt'

def setup_inputs():

    _w = (lambda a: (lambda t: t.to(torch.bfloat16) if t.is_floating_point() else t)(torch.as_tensor(a)))
    def _A_setup():
        B, L, D, N = 1, 2048, 512, 128
        A_re = -(lambda _x: torch.exp(torch.as_tensor(_x)))((lambda *s: torch.randn(*s, dtype=torch.bfloat16) * 1.6)(D, N))
        A_im = torch.pi * (lambda *s: torch.randn(*s, dtype=torch.bfloat16) * 0.2)(D, N)
        B_re = (lambda *s: torch.randn(*s, dtype=torch.bfloat16) * 0.2)(D, N)
        B_im = (lambda *s: torch.randn(*s, dtype=torch.bfloat16) * 0.2)(D, N)
        C_re = (lambda *s: torch.randn(*s, dtype=torch.bfloat16) * 0.2)(D, N)
        C_im = (lambda *s: torch.randn(*s, dtype=torch.bfloat16) * 0.2)(D, N)
        log_dt = (lambda *s: torch.randn(*s, dtype=torch.bfloat16) * 0.2)(D) * 0.5 - 4.0
        Dskip = (lambda *s: torch.randn(*s, dtype=torch.bfloat16) * 0.2)(D)
        return {
            "u": _w((lambda *s: torch.randn(*s, dtype=torch.bfloat16) * 0.05)(B, L, D)),
            "A_re": _w(A_re),
            "A_im": _w(A_im),
            "B_re": _w(B_re),
            "B_im": _w(B_im),
            "C_re": _w(C_re),
            "C_im": _w(C_im),
            "log_dt": _w(log_dt),
            "Dskip": _w(Dskip),
        }
    _A_in = _A_setup()

    def _B_setup():
        B, S, D, F = 1, 2048, 512, 1792
        return {
            "x": _w((lambda *s: torch.randn(*s, dtype=torch.bfloat16) * 0.05)(B, S, D)),
            "w1": _w((lambda *s: torch.randn(*s, dtype=torch.bfloat16) * 0.05)(D, F)),
            "b1": _w((lambda *s: torch.randn(*s, dtype=torch.bfloat16) * 0.2)(F)),
            "w2": _w((lambda *s: torch.randn(*s, dtype=torch.bfloat16) * 0.05)(F, D)),
            "b2": _w((lambda *s: torch.randn(*s, dtype=torch.bfloat16) * 0.8)(D)),
        }
    _B_in = _B_setup()

    return {
        "A_u": _A_in["u"],
        "A_A_re": _A_in["A_re"],
        "A_A_im": _A_in["A_im"],
        "A_B_re": _A_in["B_re"],
        "A_B_im": _A_in["B_im"],
        "A_C_re": _A_in["C_re"],
        "A_C_im": _A_in["C_im"],
        "A_log_dt": _A_in["log_dt"],
        "A_Dskip": _A_in["Dskip"],
        "B_x": _B_in["x"],
        "B_w1": _B_in["w1"],
        "B_b1": _B_in["b1"],
        "B_w2": _B_in["w2"],
        "B_b2": _B_in["b2"],
    }

def reference(A_u, A_A_re, A_A_im, A_B_re, A_B_im, A_C_re, A_C_im, A_log_dt, A_Dskip, B_x, B_w1, B_b1, B_w2, B_b2):
    def _A_ref(u, A_re, A_im, B_re, B_im, C_re, C_im, log_dt, Dskip):
        Bsz, L, D = u.shape
        dt = torch.exp(log_dt)[:, None]
        A = A_re + 1j * A_im
        Bc = B_re + 1j * B_im
        Cc = C_re + 1j * C_im
        logdA = dt * A
        dB = dt * Bc
        l = (lambda x, dt: x.to(dt))(torch.arange(L), A_re.dtype)
        P = torch.exp(logdA[:, :, None] * l[None, None, :])
        K = torch.einsum("dn,dnl,dn->dl", Cc, P, dB).real
        L2 = 2 * L
        Kp = _pad(K, ((0, 0), (0, L)))
        up = (lambda x, *d: x.permute(*d))(u, 0, 2, 1)
        up = _pad(up, ((0, 0), (0, 0), (0, L)))
        Kf = (lambda x, axes=(-2,-1): torch.fft.rfft2(x.float(), dim=axes))(Kp[:, None, :], axes=(-2, -1))
        Uf = (lambda x, axes=(-2,-1): torch.fft.rfft2(x.float(), dim=axes))(up[:, :, None, :], axes=(-2, -1))
        Yf = Uf * Kf[None, :, :, :]
        y = (lambda x, s, axes=(-2,-1): torch.fft.irfft2(x, s=s, dim=axes).to(torch.bfloat16))(Yf, (1, L2), axes=(-2, -1))[:, :, 0, :L]
        y = (lambda x, *d: x.permute(*d))(y, 0, 2, 1) + u * Dskip[None, None, :]
        return y

    def _B_ref(x, w1, b1, w2, b2):
        h = torch.einsum("bsd,df->bsf", x, w1) + b1
        zero = torch.zeros_like(h)
        r = torch.where(h > zero, h, zero)
        h = r * r
        out = torch.einsum("bsf,fd->bsd", h, w2) + b2
        return out

    x = A_u
    x = x + _A_ref(_layernorm(x, axis=-1), A_A_re, A_A_im, A_B_re, A_B_im, A_C_re, A_C_im, A_log_dt, A_Dskip)
    x = x + _B_ref(_layernorm(x, axis=-1), B_w1, B_b1, B_w2, B_b2)
    x = x + _A_ref(_layernorm(x, axis=-1), A_A_re, A_A_im, A_B_re, A_B_im, A_C_re, A_C_im, A_log_dt, A_Dskip)
    x = x + _B_ref(_layernorm(x, axis=-1), B_w1, B_b1, B_w2, B_b2)
    return x
```

```asm
; @launch grid=(256,1,1) block=(256,1,1) lds=163840
.amdgcn_target "amdgcn-amd-amdhsa--gfx950"
.text
.globl interleave_layers__ssm_conv_s4__dense_activation_squared_relu__prompt_kernel
.p2align 8
.type interleave_layers__ssm_conv_s4__dense_activation_squared_relu__prompt_kernel,@function
interleave_layers__ssm_conv_s4__dense_activation_squared_relu__prompt_kernel:
    s_getpc_b64 s[4:5]
L_pc:
    s_cmp_ge_u32 s2, 256
    s_cbranch_scc1 L_end
    s_load_dwordx16 s[40:55], s[0:1], 0
    s_load_dwordx16 s[76:91], s[0:1], 64
    s_load_dwordx2 s[56:57], s[0:1], 128
    v_lshlrev_b32 v8, 4, v0
    s_lshr_b32 s59, s2, 3
    s_and_b32 s58, s59, 7
    s_add_u32 s58, s58, 1
    s_lshl_b32 s58, s58, 12
    global_load_dwordx4 v[96:99], v8, s[4:5]
    v_add_u32 v9, s58, v8
    v_min_u32 v9, L_code_end-L_pc-16, v9
    global_load_dwordx4 v[100:103], v9, s[4:5]
    v_lshrrev_b32 v1, 6, v0
    v_and_b32 v2, 63, v0
    v_lshlrev_b32 v3, 1, v0
    v_lshrrev_b32 v4, 7, v0
    v_lshlrev_b32 v4, 1, v4
    v_readfirstlane_b32 s3, v1
    v_lshrrev_b32 v5, 5, v0
    v_and_b32 v6, 31, v0
    v_lshlrev_b32 v7, 10, v5
    v_lshl_add_u32 v7, v6, 4, v7
    s_lshl_b32 s58, s2, 9
    s_lshl_b32 s61, s2, 2
    s_lshl_b32 s60, s2, 13
    v_lshrrev_b32 v28, 4, v2
    v_and_b32 v29, 15, v0
    v_lshlrev_b32 v29, 4, v29
    v_lshl_add_u32 v9, v28, 10, v29
    s_mov_b32 s27, 0x20000
    s_mov_b32 s26, 1024
    s_waitcnt lgkmcnt(0)
    s_mov_b32 s24, s54
    s_and_b32 s25, s55, 0xffff
    buffer_load_ushort v16, v4, s[24:27], s61 offen
    s_mov_b32 s26, 0x20000
    s_mov_b32 s24, s42
    s_and_b32 s25, s43, 0xffff
    buffer_load_ushort v10, v3, s[24:27], s58 offen
    s_mov_b32 s24, s44
    s_and_b32 s25, s45, 0xffff
    buffer_load_ushort v11, v3, s[24:27], s58 offen
    s_mov_b32 s24, s46
    s_and_b32 s25, s47, 0xffff
    buffer_load_ushort v12, v3, s[24:27], s58 offen
    s_mov_b32 s24, s48
    s_and_b32 s25, s49, 0xffff
    buffer_load_ushort v13, v3, s[24:27], s58 offen
    s_mov_b32 s24, s50
    s_and_b32 s25, s51, 0xffff
    buffer_load_ushort v14, v3, s[24:27], s58 offen
    s_mov_b32 s24, s52
    s_and_b32 s25, s53, 0xffff
    buffer_load_ushort v15, v3, s[24:27], s58 offen
    s_mov_b32 s24, s40
    s_and_b32 s25, s41, 0xffff
    s_mov_b32 s26, 0x200000
    buffer_load_dwordx4 v[20:23], v7, s[24:27], s60 offen
    buffer_load_dwordx4 v[24:27], v7, s[24:27], s60 offen offset:512
    s_mov_b32 s24, s84
    s_and_b32 s25, s85, 0xffff
    s_mov_b32 s26, 1835008
    s_lshl_b32 s62, s3, 11
    s_add_u32 m0, s62, 145408
    s_lshr_b32 s58, s2, 2
    s_lshl_b32 s58, s58, 15
    s_and_b32 s63, s2, 3
    s_lshl_b32 s63, s63, 8
    s_add_u32 s58, s58, s63
    s_lshl_b32 s63, s3, 13
    s_add_u32 s58, s58, s63
    buffer_load_dwordx4 v9, s[24:27], s58 offen lds
    s_add_u32 m0, m0, 1024
    s_add_u32 s58, s58, 4096
    buffer_load_dwordx4 v9, s[24:27], s58 offen lds
    s_and_b32 s58, s2, 7
    s_lshl_b32 s31, s58, 1
    s_and_b32 s60, s59, 1
    s_add_u32 s31, s31, s60
    s_lshr_b32 s32, s59, 1
    s_and_b32 s33, s32, 1
    s_lshr_b32 s34, s59, 2
    s_mov_b32 s24, s82
    s_and_b32 s25, s83, 0xffff
    s_mov_b32 s26, 3584
    s_lshl_b32 s63, s32, 8
    s_lshl_b32 s58, s3, 6
    s_add_u32 s63, s63, s58
    v_lshlrev_b32 v9, 1, v6
    buffer_load_ushort v117, v9, s[24:27], s63 offen
    s_load_dword s28, s[76:77], s61
    s_mov_b32 s24, s80
    s_and_b32 s25, s81, 0xffff
    s_mov_b32 s26, 1835008
    s_lshl_b32 s46, s3, 12
    v_lshrrev_b32 v29, 4, v2
    v_mul_u32_u24 v114, 3584, v29
    v_lshlrev_b32 v29, 2, v29
    v_and_b32 v30, 15, v0
    v_xor_b32 v29, v29, v30
    v_lshl_add_u32 v114, v29, 4, v114
    s_mul_i32 s47, s3, 57344
    s_lshl_b32 s45, s32, 8
    s_add_u32 s47, s47, s45
    s_mov_b32 s8, s56
    s_and_b32 s9, s57, 0xffff
    s_mov_b32 s10, 0x1bc0000
    s_mov_b32 s11, 0x20000
    s_mov_b32 s16, s88
    s_and_b32 s17, s89, 0xffff
    s_mov_b32 s18, 0x200000
    s_mov_b32 s19, 0x20000
    s_mov_b32 s20, s86
    s_and_b32 s21, s87, 0xffff
    s_mov_b32 s22, 0x400
    s_mov_b32 s23, 0x20000
    s_mov_b32 s6, s90
    s_mov_b32 s7, s91
    s_mov_b32 s29, 0
    s_mov_b32 s30, 0x40000
    s_mov_b32 s39, 0
    s_mov_b32 s36, 0x200000
    s_mov_b32 s37, 0x800000
    s_mov_b32 s38, 0x1806000
    v_mov_b32 v28, 0
    v_mov_b32 v29, 0
    v_mov_b32 v30, 0
    v_mov_b32 v31, 0
    s_lshl_b32 s58, s2, 8
    s_add_u32 s58, s58, 0x1802000
    v_cmp_gt_u32 vcc, 16, v0
    s_and_b64 exec, exec, vcc
    buffer_store_dwordx4 v[28:31], v8, s[8:11], s58 offen sc1
    s_mov_b64 exec, -1
    s_nop 1
    v_subrev_u32 v28, 16, v6
    v_lshlrev_b32 v28, 2, v28
    v_add_u32 v28, 512, v28
    v_subrev_u32 v29, 20, v6
    v_and_b32 v30, 1, v29
    v_lshrrev_b32 v29, 1, v29
    v_lshlrev_b32 v29, 9, v29
    v_lshl_add_u32 v29, v30, 3, v29
    v_add_u32 v29, 1024, v29
    v_cmp_le_u32 vcc, 16, v6
    v_cmp_le_u32 s[60:61], 20, v6
    s_nop 0
    v_cndmask_b32 v40, v6, v28, vcc
    v_cndmask_b32 v40, v40, v29, s[60:61]
    v_cvt_f32_u32 v40, v40
    v_lshlrev_b32 v41, 4, v6
    v_cvt_f32_u32 v41, v41
    v_bfe_u32 v28, v0, 5, 1
    v_and_b32 v29, 3, v0
    v_bfe_u32 v30, v0, 2, 2
    v_bfe_u32 v31, v0, 4, 1
    v_lshlrev_b32 v42, 10, v1
    v_lshl_add_u32 v42, v28, 4, v42
    v_add_u32 v42, 131072, v42
    v_add_u32 v43, 131072, v8
    v_mul_u32_u24 v46, 1088, v5
    v_lshl_add_u32 v46, v6, 4, v46
    v_add_u32 v46, 131072, v46
    v_mul_u32_u24 v47, 1088, v30
    v_lshl_add_u32 v47, v29, 3, v47
    v_bfe_u32 v44, v0, 4, 2
    v_lshl_add_u32 v47, v44, 5, v47
    v_lshl_add_u32 v47, v1, 8, v47
    v_add_u32 v47, 131072, v47
    v_lshlrev_b32 v116, 4, v2
    v_lshl_add_u32 v48, v1, 11, v116
    v_lshlrev_b32 v44, 5, v31
    v_lshl_add_u32 v44, v29, 3, v44
    v_lshl_add_u32 v45, v28, 3, v30
    v_lshl_add_u32 v45, v45, 8, v44
    v_xor_b32 v115, v1, v30
    v_lshl_add_u32 v45, v115, 6, v45
    v_add_u32 v115, 0x10000, v45
    v_lshl_add_u32 v44, v1, 6, v44
    v_lshl_add_u32 v44, v30, 8, v44
    v_lshl_add_u32 v49, v28, 10, v44
    v_add_u32 v49, 131072, v49
    s_mov_b32 s58, 131072
    v_add_u32 v18, 0, v0
    v_add_u32 v19, 256, v0
    v_cvt_f32_u32 v18, v18
    v_cvt_f32_u32 v19, v19
    v_cvt_pk_bf16_f32 v18, v18, v19
    v_and_b32 v19, 0xffff0000, v18
    v_lshlrev_b32 v18, 16, v18
    v_cvt_u32_f32 v18, v18
    v_cvt_u32_f32 v19, v19
    v_lshl_add_u32 v32, v18, 2, s58
    v_add_u32 v104, 132608, v18
    v_lshrrev_b32 v18, 1, v18
    v_add_u32 v18, 133120, v18
    v_min3_u32 v104, v32, v104, v18
    v_lshl_add_u32 v32, v19, 2, s58
    v_add_u32 v105, 132608, v19
    v_lshrrev_b32 v19, 1, v19
    v_add_u32 v19, 133120, v19
    v_min3_u32 v105, v32, v105, v19
    v_add_u32 v18, 512, v0
    v_add_u32 v19, 768, v0
    v_cvt_f32_u32 v18, v18
    v_cvt_f32_u32 v19, v19
    v_cvt_pk_bf16_f32 v18, v18, v19
    v_and_b32 v19, 0xffff0000, v18
    v_lshlrev_b32 v18, 16, v18
    v_cvt_u32_f32 v18, v18
    v_cvt_u32_f32 v19, v19
    v_lshl_add_u32 v32, v18, 2, s58
    v_add_u32 v106, 132608, v18
    v_lshrrev_b32 v18, 1, v18
    v_add_u32 v18, 133120, v18
    v_min3_u32 v106, v32, v106, v18
    v_lshl_add_u32 v32, v19, 2, s58
    v_add_u32 v107, 132608, v19
    v_lshrrev_b32 v19, 1, v19
    v_add_u32 v19, 133120, v19
    v_min3_u32 v107, v32, v107, v19
    v_add_u32 v18, 1024, v0
    v_add_u32 v19, 1280, v0
    v_cvt_f32_u32 v18, v18
    v_cvt_f32_u32 v19, v19
    v_cvt_pk_bf16_f32 v18, v18, v19
    v_and_b32 v19, 0xffff0000, v18
    v_lshlrev_b32 v18, 16, v18
    v_cvt_u32_f32 v18, v18
    v_cvt_u32_f32 v19, v19
    v_lshl_add_u32 v32, v18, 2, s58
    v_add_u32 v108, 132608, v18
    v_lshrrev_b32 v18, 1, v18
    v_add_u32 v18, 133120, v18
    v_min3_u32 v108, v32, v108, v18
    v_lshl_add_u32 v32, v19, 2, s58
    v_add_u32 v109, 132608, v19
    v_lshrrev_b32 v19, 1, v19
    v_add_u32 v19, 133120, v19
    v_min3_u32 v109, v32, v109, v19
    v_add_u32 v18, 1536, v0
    v_add_u32 v19, 1792, v0
    v_cvt_f32_u32 v18, v18
    v_cvt_f32_u32 v19, v19
    v_cvt_pk_bf16_f32 v18, v18, v19
    v_and_b32 v19, 0xffff0000, v18
    v_lshlrev_b32 v18, 16, v18
    v_cvt_u32_f32 v18, v18
    v_cvt_u32_f32 v19, v19
    v_lshl_add_u32 v32, v18, 2, s58
    v_add_u32 v110, 132608, v18
    v_lshrrev_b32 v18, 1, v18
    v_add_u32 v18, 133120, v18
    v_min3_u32 v110, v32, v110, v18
    v_lshl_add_u32 v32, v19, 2, s58
    v_add_u32 v111, 132608, v19
    v_lshrrev_b32 v19, 1, v19
    v_add_u32 v19, 133120, v19
    v_min3_u32 v111, v32, v111, v19
    v_mov_b32 v64, 0
    v_mov_b32 v65, 0
    v_mov_b32 v66, 0
    v_mov_b32 v67, 0
    v_mov_b32 v68, 0
    v_mov_b32 v69, 0
    v_mov_b32 v70, 0
    v_mov_b32 v71, 0
    v_mov_b32 v72, 0
    v_mov_b32 v73, 0
    v_mov_b32 v74, 0
    v_mov_b32 v75, 0
    v_mov_b32 v76, 0
    v_mov_b32 v77, 0
    v_mov_b32 v78, 0
    v_mov_b32 v79, 0
    s_mov_b32 s58, 0x3fb8aa3b
    s_mov_b32 s59, 0x32a57060
    s_mov_b32 s60, 0x3f317218
    s_waitcnt vmcnt(6)
    s_mul_i32 s44, s2, 7168
    s_add_u32 s45, s44, 4096
    buffer_load_dwordx4 v[56:59], v8, s[24:27], s44 offen
    buffer_load_dwordx4 v[56:59], v8, s[24:27], s45 offen
    s_add_u32 m0, s46, 0
    s_add_u32 s45, s47, 0
    buffer_load_dwordx4 v114, s[24:27], s45 offen lds
    s_add_u32 m0, s46, 1024
    s_add_u32 s45, s47, 14336
    buffer_load_dwordx4 v114, s[24:27], s45 offen lds
    s_add_u32 m0, s46, 2048
    s_add_u32 s45, s47, 28672
    buffer_load_dwordx4 v114, s[24:27], s45 offen lds
    s_add_u32 m0, s46, 3072
    s_add_u32 s45, s47, 43008
    buffer_load_dwordx4 v114, s[24:27], s45 offen lds
    v_lshlrev_b32 v10, 16, v10
    v_lshlrev_b32 v11, 16, v11
    v_lshlrev_b32 v12, 16, v12
    v_lshlrev_b32 v13, 16, v13
    v_lshlrev_b32 v14, 16, v14
    v_lshlrev_b32 v15, 16, v15
    v_lshlrev_b32 v16, 16, v16
    v_mul_f32 v17, s58, v16
    v_fma_f32 v18, v16, s58, -v17
    v_fmac_f32 v18, s59, v16
    v_exp_f32 v17, v17
    s_nop 0
    v_mul_f32 v18, v18, v17
    v_fmac_f32 v17, s60, v18
    v_cvt_pk_bf16_f32 v17, v17, v17
    v_lshlrev_b32 v17, 16, v17
    v_mul_f32 v32, v17, v10
    v_mul_f32 v32, s58, v32
    v_mul_f32 v33, v17, v11
    v_mul_f32 v33, 0.15915494, v33
    v_rndne_f32 v18, v33
    v_sub_f32 v33, v33, v18
    v_mul_f32 v12, v17, v12
    v_mul_f32 v13, v17, v13
    v_mul_f32 v34, v14, v12
    v_fma_f32 v34, -v15, v13, v34
    v_mul_f32 v35, v14, v13
    v_fmac_f32 v35, v15, v12
    ds_write_b128 v43, v[32:35] offset:0
    v_max_f32_e64 v17, abs(v34), abs(v35)
    s_mov_b32 s58, 0x3f803f80
    v_mov_b32 v10, 0
    v_mov_b32 v11, 0
    v_max_f32 v19, 0, v32
    s_waitcnt vmcnt(10)
    ds_write_b128 v46, v[20:23] offset:4096
    ds_write_b128 v46, v[24:27] offset:4608
    v_dot2_f32_bf16 v10, v20, s58, v10
    v_dot2_f32_bf16 v11, v20, v20, v11
    v_dot2_f32_bf16 v10, v21, s58, v10
    v_dot2_f32_bf16 v11, v21, v21, v11
    v_dot2_f32_bf16 v10, v22, s58, v10
    v_dot2_f32_bf16 v11, v22, v22, v11
    v_dot2_f32_bf16 v10, v23, s58, v10
    v_dot2_f32_bf16 v11, v23, v23, v11
    v_dot2_f32_bf16 v10, v24, s58, v10
    v_dot2_f32_bf16 v11, v24, v24, v11
    v_dot2_f32_bf16 v10, v25, s58, v10
    v_dot2_f32_bf16 v11, v25, v25, v11
    v_dot2_f32_bf16 v10, v26, s58, v10
    v_dot2_f32_bf16 v11, v26, v26, v11
    v_dot2_f32_bf16 v10, v27, s58, v10
    v_dot2_f32_bf16 v11, v27, v27, v11
    s_nop 0
    v_max_f32_dpp v17, v17, v17 quad_perm:[1,0,3,2] row_mask:0xf bank_mask:0xf
    v_max_f32_dpp v19, v19, v19 quad_perm:[1,0,3,2] row_mask:0xf bank_mask:0xf
    v_add_f32_dpp v10, v10, v10 quad_perm:[1,0,3,2] row_mask:0xf bank_mask:0xf
    v_add_f32_dpp v11, v11, v11 quad_perm:[1,0,3,2] row_mask:0xf bank_mask:0xf
    v_max_f32_dpp v17, v17, v17 quad_perm:[2,3,0,1] row_mask:0xf bank_mask:0xf
    v_max_f32_dpp v19, v19, v19 quad_perm:[2,3,0,1] row_mask:0xf bank_mask:0xf
    v_add_f32_dpp v10, v10, v10 quad_perm:[2,3,0,1] row_mask:0xf bank_mask:0xf
    v_add_f32_dpp v11, v11, v11 quad_perm:[2,3,0,1] row_mask:0xf bank_mask:0xf
    v_max_f32_dpp v17, v17, v17 row_half_mirror row_mask:0xf bank_mask:0xf
    v_max_f32_dpp v19, v19, v19 row_half_mirror row_mask:0xf bank_mask:0xf
    v_add_f32_dpp v10, v10, v10 row_half_mirror row_mask:0xf bank_mask:0xf
    v_add_f32_dpp v11, v11, v11 row_half_mirror row_mask:0xf bank_mask:0xf
    v_max_f32_dpp v17, v17, v17 row_mirror row_mask:0xf bank_mask:0xf
    v_max_f32_dpp v19, v19, v19 row_mirror row_mask:0xf bank_mask:0xf
    v_add_f32_dpp v10, v10, v10 row_mirror row_mask:0xf bank_mask:0xf
    v_add_f32_dpp v11, v11, v11 row_mirror row_mask:0xf bank_mask:0xf
    v_mov_b32 v18, v17
    v_mov_b32 v12, v10
    v_mov_b32 v13, v11
    s_nop 0
    v_permlane16_swap_b32 v17, v18
    v_permlane16_swap_b32 v10, v12
    v_permlane16_swap_b32 v11, v13
    s_nop 0
    v_max_f32 v17, v17, v18
    v_add_f32 v10, v10, v12
    v_add_f32 v11, v11, v13
    v_mov_b32 v18, v17
    s_nop 1
    v_permlane32_swap_b32 v17, v18
    s_nop 1
    v_max_f32 v17, v17, v18
    v_mov_b32 v18, v19
    s_nop 1
    v_permlane16_swap_b32 v19, v18
    s_nop 0
    v_max_f32 v19, v19, v18
    v_mov_b32 v18, v19
    s_nop 1
    v_permlane32_swap_b32 v19, v18
    s_nop 0
    v_max_f32 v19, v19, v18
    v_lshlrev_b32 v18, 2, v1
    v_add_u32 v18, 161824, v18
    ds_write_b32 v18, v17
    ds_write_b32 v18, v19 offset:16
    v_mul_f32 v10, 0x3b000000, v10
    v_mul_f32 v11, 0x3b000000, v11
    v_fma_f32 v11, -v10, v10, v11
    v_max_f32 v11, 0, v11
    v_cvt_pk_bf16_f32 v10, v10, v11
    v_and_b32 v11, 0xffff0000, v10
    v_lshlrev_b32 v10, 16, v10
    v_add_f32 v11, 0x3727c5ac, v11
    v_cvt_pk_bf16_f32 v11, v11, v11
    v_lshlrev_b32 v11, 16, v11
    v_sqrt_f32 v11, v11
    s_nop 0
    v_cvt_pk_bf16_f32 v11, v11, v11
    v_lshlrev_b32 v11, 16, v11
    v_cvt_pk_bf16_f32 v10, v10, v11
    v_lshlrev_b32 v12, 2, v5
    s_lshl_b32 s58, s2, 5
    s_add_u32 s58, s58, 0x1800000
    s_lshl_b32 s59, s2, 13
    s_and_b32 s62, s2, 3
    s_lshl_b32 s62, s62, 2
    s_add_u32 s62, s62, s3
    s_mul_i32 s62, s62, 114688
    s_lshr_b32 s63, s2, 2
    s_lshl_b32 s63, s63, 11
    s_add_u32 s62, s62, s63
    s_add_u32 s62, s62, 0x1840000
    s_cmp_ge_u32 s2, 224
    s_cselect_b32 s62, 0x40000000, s62
    s_waitcnt vmcnt(8) lgkmcnt(0)
    s_barrier
    v_mov_b32 v18, 161824
    ds_read_b128 v[88:91], v18
    ds_read_b128 v[92:95], v18 offset:16
    ds_read_b128 v[36:39], v42 offset:0
    ds_read_b64_tr_b16 v[20:21], v47 offset:4096
    ds_read_b64_tr_b16 v[22:23], v47 offset:8448
    ds_read_b64_tr_b16 v[24:25], v47 offset:4224
    ds_read_b64_tr_b16 v[26:27], v47 offset:8576
    ds_read_b64_tr_b16 v[96:97], v49 offset:14336
    ds_read_b64_tr_b16 v[98:99], v49 offset:16384
    ds_read_b64_tr_b16 v[100:101], v49 offset:18432
    ds_read_b64_tr_b16 v[102:103], v49 offset:20480
    v_cmp_eq_u32 vcc, 0, v6
    s_and_b64 exec, exec, vcc
    buffer_store_dword v10, v12, s[8:11], s58 offen sc1
    s_mov_b64 exec, -1
    s_waitcnt lgkmcnt(9)
    v_max_f32 v88, v88, v89
    v_max_f32 v90, v90, v91
    v_frexp_exp_i32_f32 v88, v88
    v_frexp_exp_i32_f32 v90, v90
    v_max_f32 v122, v92, v93
    v_max_f32 v123, v94, v95
    v_subrev_u32 v92, 24, v88
    v_subrev_u32 v93, 24, v90
    v_ldexp_f32 v112, 1.0, v92
    v_ldexp_f32 v113, 1.0, v93
    s_cmp_lt_u32 s3, 2
    s_cselect_b64 vcc, -1, 0
    v_cndmask_b32 v62, v90, v88, vcc
    v_sub_u32 v62, 12, v62
    v_cvt_f32_i32 v62, v62
    v_mov_b32 v63, 0
    v_mov_b32 v54, 0x41400000
    v_mov_b32 v55, 0
    v_cndmask_b32 v92, v123, v122, vcc
    v_fma_f32 v62, -v92, v40, v62
    v_fma_f32 v54, -v92, v41, v54
    v_or_b32 v92, v122, v123
    s_nop 0
    v_readfirstlane_b32 s48, v92
    s_waitcnt lgkmcnt(6)
    buffer_store_dwordx4 v[20:23], v48, s[8:11], s59 offen sc1
    s_waitcnt lgkmcnt(4)
    buffer_store_dwordx4 v[24:27], v48, s[8:11], s59 offen offset:1024 sc1
    s_waitcnt lgkmcnt(0)
    buffer_store_dwordx4 v[96:99], v116, s[8:11], s62 offen sc1
    buffer_store_dwordx4 v[100:103], v116, s[8:11], s62 offen offset:1024 sc1
    s_waitcnt vmcnt(9)
    s_waitcnt lgkmcnt(0)
    ds_read_b128 v[32:35], v42 offset:32
    v_pk_fma_f32 v[48:49], v[36:37], v[40:41], v[62:63] op_sel_hi:[1,0,1]
    v_pk_fma_f32 v[50:51], v[36:37], v[40:41], v[54:55] op_sel:[0,1,0] op_sel_hi:[1,1,1]
    v_fract_f32 v49, v49
    v_cos_f32 v58, v51
    v_sin_f32 v59, v51
    v_exp_f32 v50, v50
    s_add_u32 m0, s46, 16384
    s_add_u32 s45, s47, 229376
    buffer_load_dwordx4 v114, s[24:27], s45 offen lds
    v_cos_f32 v56, v49
    v_sin_f32 v57, v49
    v_exp_f32 v48, v48
    s_add_u32 m0, s46, 17408
    s_add_u32 s45, s47, 243712
    buffer_load_dwordx4 v114, s[24:27], s45 offen lds
    s_waitcnt lgkmcnt(0)
    ds_read_b128 v[28:31], v42 offset:64
    v_pk_fma_f32 v[88:89], v[32:33], v[40:41], v[62:63] op_sel_hi:[1,0,1]
    v_pk_fma_f32 v[90:91], v[32:33], v[40:41], v[54:55] op_sel:[0,1,0] op_sel_hi:[1,1,1]
    v_fract_f32 v89, v89
    v_cos_f32 v94, v91
    v_pk_mul_f32 v[60:61], v[38:39], v[56:57] op_sel_hi:[0,1]
    v_sin_f32 v95, v91
    v_pk_mul_f32 v[58:59], v[50:51], v[58:59] op_sel_hi:[0,1] neg_hi:[1,0]
    v_exp_f32 v90, v90
    v_pk_fma_f32 v[60:61], v[38:39], v[56:57], v[60:61] op_sel:[1,1,0] op_sel_hi:[1,0,1] neg_lo:[1,0,0]
    s_add_u32 m0, s46, 18432
    s_add_u32 s45, s47, 258048
    buffer_load_dwordx4 v114, s[24:27], s45 offen lds
    v_cos_f32 v92, v89
    v_cvt_pk_f16_f32 v84, v58, v59
    v_sin_f32 v93, v89
    v_pk_mul_f32 v[60:61], v[48:49], v[60:61] op_sel_hi:[0,1]
    v_exp_f32 v88, v88
    v_cvt_pk_f16_f32 v80, v60, v61
    s_add_u32 m0, s46, 19456
    s_add_u32 s45, s47, 272384
    buffer_load_dwordx4 v114, s[24:27], s45 offen lds
    s_waitcnt lgkmcnt(0)
    ds_read_b128 v[36:39], v42 offset:96
    v_pk_fma_f32 v[48:49], v[28:29], v[40:41], v[62:63] op_sel_hi:[1,0,1]
    v_pk_fma_f32 v[50:51], v[28:29], v[40:41], v[54:55] op_sel:[0,1,0] op_sel_hi:[1,1,1]
    v_fract_f32 v49, v49
    v_cos_f32 v58, v51
    v_pk_mul_f32 v[60:61], v[34:35], v[92:93] op_sel_hi:[0,1]
    v_sin_f32 v59, v51
    v_pk_mul_f32 v[94:95], v[90:91], v[94:95] op_sel_hi:[0,1] neg_hi:[1,0]
    v_exp_f32 v50, v50
    v_pk_fma_f32 v[60:61], v[34:35], v[92:93], v[60:61] op_sel:[1,1,0] op_sel_hi:[1,0,1] neg_lo:[1,0,0]
    s_add_u32 m0, s46, 32768
    s_add_u32 s45, s47, 458752
    buffer_load_dwordx4 v114, s[24:27], s45 offen lds
    v_cos_f32 v56, v49
    v_cvt_pk_f16_f32 v85, v94, v95
    v_sin_f32 v57, v49
    v_pk_mul_f32 v[60:61], v[88:89], v[60:61] op_sel_hi:[0,1]
    v_exp_f32 v48, v48
    v_cvt_pk_f16_f32 v81, v60, v61
    s_add_u32 m0, s46, 33792
    s_add_u32 s45, s47, 473088
    buffer_load_dwordx4 v114, s[24:27], s45 offen lds
    s_waitcnt lgkmcnt(0)
    ds_read_b128 v[32:35], v42 offset:128
    v_pk_fma_f32 v[88:89], v[36:37], v[40:41], v[62:63] op_sel_hi:[1,0,1]
    v_pk_fma_f32 v[90:91], v[36:37], v[40:41], v[54:55] op_sel:[0,1,0] op_sel_hi:[1,1,1]
    v_fract_f32 v89, v89
    v_cos_f32 v94, v91
    v_pk_mul_f32 v[60:61], v[30:31], v[56:57] op_sel_hi:[0,1]
    v_sin_f32 v95, v91
    v_pk_mul_f32 v[58:59], v[50:51], v[58:59] op_sel_hi:[0,1] neg_hi:[1,0]
    v_exp_f32 v90, v90
    v_pk_fma_f32 v[60:61], v[30:31], v[56:57], v[60:61] op_sel:[1,1,0] op_sel_hi:[1,0,1] neg_lo:[1,0,0]
    s_add_u32 m0, s46, 34816
    s_add_u32 s45, s47, 487424
    buffer_load_dwordx4 v114, s[24:27], s45 offen lds
    v_cos_f32 v92, v89
    v_cvt_pk_f16_f32 v86, v58, v59
    v_sin_f32 v93, v89
    v_pk_mul_f32 v[60:61], v[48:49], v[60:61] op_sel_hi:[0,1]
    v_exp_f32 v88, v88
    v_cvt_pk_f16_f32 v82, v60, v61
    s_add_u32 m0, s46, 35840
    s_add_u32 s45, s47, 501760
    buffer_load_dwordx4 v114, s[24:27], s45 offen lds
    s_waitcnt lgkmcnt(0)
    ds_read_b128 v[28:31], v42 offset:160
    v_pk_fma_f32 v[48:49], v[32:33], v[40:41], v[62:63] op_sel_hi:[1,0,1]
    v_pk_fma_f32 v[50:51], v[32:33], v[40:41], v[54:55] op_sel:[0,1,0] op_sel_hi:[1,1,1]
    v_fract_f32 v49, v49
    v_cos_f32 v58, v51
    v_pk_mul_f32 v[60:61], v[38:39], v[92:93] op_sel_hi:[0,1]
    v_sin_f32 v59, v51
    v_pk_mul_f32 v[94:95], v[90:91], v[94:95] op_sel_hi:[0,1] neg_hi:[1,0]
    v_exp_f32 v50, v50
    v_pk_fma_f32 v[60:61], v[38:39], v[92:93], v[60:61] op_sel:[1,1,0] op_sel_hi:[1,0,1] neg_lo:[1,0,0]
    s_add_u32 m0, s46, 49152
    s_add_u32 s45, s47, 688128
    buffer_load_dwordx4 v114, s[24:27], s45 offen lds
    v_cos_f32 v56, v49
    v_cvt_pk_f16_f32 v87, v94, v95
    v_sin_f32 v57, v49
    v_pk_mul_f32 v[60:61], v[88:89], v[60:61] op_sel_hi:[0,1]
    v_exp_f32 v48, v48
    v_cvt_pk_f16_f32 v83, v60, v61
    s_add_u32 m0, s46, 50176
    s_add_u32 s45, s47, 702464
    buffer_load_dwordx4 v114, s[24:27], s45 offen lds
    s_nop 1
    v_mfma_f32_32x32x16_f16 v[64:79], v[80:83], v[84:87], v[64:79]
    s_waitcnt lgkmcnt(0)
    ds_read_b128 v[36:39], v42 offset:192
    v_pk_fma_f32 v[88:89], v[28:29], v[40:41], v[62:63] op_sel_hi:[1,0,1]
    v_pk_fma_f32 v[90:91], v[28:29], v[40:41], v[54:55] op_sel:[0,1,0] op_sel_hi:[1,1,1]
    v_fract_f32 v89, v89
    v_cos_f32 v94, v91
    v_pk_mul_f32 v[60:61], v[34:35], v[56:57] op_sel_hi:[0,1]
    v_sin_f32 v95, v91
    v_pk_mul_f32 v[58:59], v[50:51], v[58:59] op_sel_hi:[0,1] neg_hi:[1,0]
    v_exp_f32 v90, v90
    v_pk_fma_f32 v[60:61], v[34:35], v[56:57], v[60:61] op_sel:[1,1,0] op_sel_hi:[1,0,1] neg_lo:[1,0,0]
    s_add_u32 m0, s46, 51200
    s_add_u32 s45, s47, 716800
    buffer_load_dwordx4 v114, s[24:27], s45 offen lds
    v_cos_f32 v92, v89
    v_cvt_pk_f16_f32 v84, v58, v59
    v_sin_f32 v93, v89
    v_pk_mul_f32 v[60:61], v[48:49], v[60:61] op_sel_hi:[0,1]
    v_exp_f32 v88, v88
    v_cvt_pk_f16_f32 v80, v60, v61
    s_add_u32 m0, s46, 52224
    s_add_u32 s45, s47, 731136
    buffer_load_dwordx4 v114, s[24:27], s45 offen lds
    s_waitcnt lgkmcnt(0)
    ds_read_b128 v[32:35], v42 offset:224
    v_pk_fma_f32 v[48:49], v[36:37], v[40:41], v[62:63] op_sel_hi:[1,0,1]
    v_pk_fma_f32 v[50:51], v[36:37], v[40:41], v[54:55] op_sel:[0,1,0] op_sel_hi:[1,1,1]
    v_fract_f32 v49, v49
    v_cos_f32 v58, v51
    v_pk_mul_f32 v[60:61], v[30:31], v[92:93] op_sel_hi:[0,1]
    v_sin_f32 v59, v51
    v_pk_mul_f32 v[94:95], v[90:91], v[94:95] op_sel_hi:[0,1] neg_hi:[1,0]
    v_exp_f32 v50, v50
    v_pk_fma_f32 v[60:61], v[30:31], v[92:93], v[60:61] op_sel:[1,1,0] op_sel_hi:[1,0,1] neg_lo:[1,0,0]
    s_add_u32 m0, s46, 65536
    s_add_u32 s45, s47, 917504
    buffer_load_dwordx4 v114, s[24:27], s45 offen lds
    v_cos_f32 v56, v49
    v_cvt_pk_f16_f32 v85, v94, v95
    v_sin_f32 v57, v49
    v_pk_mul_f32 v[60:61], v[88:89], v[60:61] op_sel_hi:[0,1]
    v_exp_f32 v48, v48
    v_cvt_pk_f16_f32 v81, v60, v61
    s_waitcnt lgkmcnt(0)
    ds_read_b128 v[28:31], v42 offset:256
    v_pk_fma_f32 v[88:89], v[32:33], v[40:41], v[62:63] op_sel_hi:[1,0,1]
    v_pk_fma_f32 v[90:91], v[32:33], v[40:41], v[54:55] op_sel:[0,1,0] op_sel_hi:[1,1,1]
    v_fract_f32 v89, v89
    v_cos_f32 v94, v91
    v_pk_mul_f32 v[60:61], v[38:39], v[56:57] op_sel_hi:[0,1]
    v_sin_f32 v95, v91
    v_pk_mul_f32 v[58:59], v[50:51], v[58:59] op_sel_hi:[0,1] neg_hi:[1,0]
    v_exp_f32 v90, v90
    v_pk_fma_f32 v[60:61], v[38:39], v[56:57], v[60:61] op_sel:[1,1,0] op_sel_hi:[1,0,1] neg_lo:[1,0,0]
    s_add_u32 m0, s46, 66560
    s_add_u32 s45, s47, 931840
    buffer_load_dwordx4 v114, s[24:27], s45 offen lds
    v_cos_f32 v92, v89
    v_cvt_pk_f16_f32 v86, v58, v59
    v_sin_f32 v93, v89
    v_pk_mul_f32 v[60:61], v[48:49], v[60:61] op_sel_hi:[0,1]
    v_exp_f32 v88, v88
    v_cvt_pk_f16_f32 v82, v60, v61
    s_waitcnt lgkmcnt(0)
    ds_read_b128 v[36:39], v42 offset:288
    v_pk_fma_f32 v[48:49], v[28:29], v[40:41], v[62:63] op_sel_hi:[1,0,1]
    v_pk_fma_f32 v[50:51], v[28:29], v[40:41], v[54:55] op_sel:[0,1,0] op_sel_hi:[1,1,1]
    v_fract_f32 v49, v49
    s_waitcnt vmcnt(14)
    s_barrier
    s_mov_b32 s40, s6
    s_and_b32 s41, s7, 0xffff
    s_mov_b32 s42, 256
    s_mov_b32 s43, 0x20000
    s_and_b32 s44, s2, 3
    s_lshl_b32 s44, s44, 6
    v_mov_b32 v118, 0
    v_mov_b32 v119, 1
    s_cmp_eq_u32 s3, 0
    s_cselect_b64 exec, 1, 0
    buffer_atomic_add v119, v118, s[40:43], s44 offen sc1
    s_mov_b64 exec, -1
    v_cos_f32 v58, v51
    v_pk_mul_f32 v[60:61], v[34:35], v[92:93] op_sel_hi:[0,1]
    v_sin_f32 v59, v51
    v_pk_mul_f32 v[94:95], v[90:91], v[94:95] op_sel_hi:[0,1] neg_hi:[1,0]
    v_exp_f32 v50, v50
    v_pk_fma_f32 v[60:61], v[34:35], v[92:93], v[60:61] op_sel:[1,1,0] op_sel_hi:[1,0,1] neg_lo:[1,0,0]
    s_add_u32 m0, s46, 67584
    s_add_u32 s45, s47, 946176
    buffer_load_dwordx4 v114, s[24:27], s45 offen lds
    v_cos_f32 v56, v49
    v_cvt_pk_f16_f32 v87, v94, v95
    v_sin_f32 v57, v49
    v_pk_mul_f32 v[60:61], v[88:89], v[60:61] op_sel_hi:[0,1]
    v_exp_f32 v48, v48
    v_cvt_pk_f16_f32 v83, v60, v61
    s_nop 1
    v_mfma_f32_32x32x16_f16 v[64:79], v[80:83], v[84:87], v[64:79]
    s_waitcnt lgkmcnt(0)
    ds_read_b128 v[32:35], v42 offset:320
    v_pk_fma_f32 v[88:89], v[36:37], v[40:41], v[62:63] op_sel_hi:[1,0,1]
    v_pk_fma_f32 v[90:91], v[36:37], v[40:41], v[54:55] op_sel:[0,1,0] op_sel_hi:[1,1,1]
    v_fract_f32 v89, v89
    v_cos_f32 v94, v91
    v_pk_mul_f32 v[60:61], v[30:31], v[56:57] op_sel_hi:[0,1]
    v_sin_f32 v95, v91
    v_pk_mul_f32 v[58:59], v[50:51], v[58:59] op_sel_hi:[0,1] neg_hi:[1,0]
    v_exp_f32 v90, v90
    v_pk_fma_f32 v[60:61], v[30:31], v[56:57], v[60:61] op_sel:[1,1,0] op_sel_hi:[1,0,1] neg_lo:[1,0,0]
    s_add_u32 m0, s46, 68608
    s_add_u32 s45, s47, 960512
    buffer_load_dwordx4 v114, s[24:27], s45 offen lds
    v_cos_f32 v92, v89
    v_cvt_pk_f16_f32 v84, v58, v59
    v_sin_f32 v93, v89
    v_pk_mul_f32 v[60:61], v[48:49], v[60:61] op_sel_hi:[0,1]
    v_exp_f32 v88, v88
    v_cvt_pk_f16_f32 v80, v60, v61
    s_waitcnt lgkmcnt(0)
    ds_read_b128 v[28:31], v42 offset:352
    v_pk_fma_f32 v[48:49], v[32:33], v[40:41], v[62:63] op_sel_hi:[1,0,1]
    v_pk_fma_f32 v[50:51], v[32:33], v[40:41], v[54:55] op_sel:[0,1,0] op_sel_hi:[1,1,1]
    v_fract_f32 v49, v49
    v_cos_f32 v58, v51
    v_pk_mul_f32 v[60:61], v[38:39], v[92:93] op_sel_hi:[0,1]
    v_sin_f32 v59, v51
    v_pk_mul_f32 v[94:95], v[90:91], v[94:95] op_sel_hi:[0,1] neg_hi:[1,0]
    v_exp_f32 v50, v50
    v_pk_fma_f32 v[60:61], v[38:39], v[92:93], v[60:61] op_sel:[1,1,0] op_sel_hi:[1,0,1] neg_lo:[1,0,0]
    s_add_u32 m0, s46, 81920
    s_add_u32 s45, s47, 1146880
    buffer_load_dwordx4 v114, s[24:27], s45 offen lds
    v_cos_f32 v56, v49
    v_cvt_pk_f16_f32 v85, v94, v95
    v_sin_f32 v57, v49
    v_pk_mul_f32 v[60:61], v[88:89], v[60:61] op_sel_hi:[0,1]
    v_exp_f32 v48, v48
    v_cvt_pk_f16_f32 v81, v60, v61
    s_waitcnt lgkmcnt(0)
    ds_read_b128 v[36:39], v42 offset:384
    v_pk_fma_f32 v[88:89], v[28:29], v[40:41], v[62:63] op_sel_hi:[1,0,1]
    v_pk_fma_f32 v[90:91], v[28:29], v[40:41], v[54:55] op_sel:[0,1,0] op_sel_hi:[1,1,1]
    v_fract_f32 v89, v89
    v_cos_f32 v94, v91
    v_pk_mul_f32 v[60:61], v[34:35], v[56:57] op_sel_hi:[0,1]
    v_sin_f32 v95, v91
    v_pk_mul_f32 v[58:59], v[50:51], v[58:59] op_sel_hi:[0,1] neg_hi:[1,0]
    v_exp_f32 v90, v90
    v_pk_fma_f32 v[60:61], v[34:35], v[56:57], v[60:61] op_sel:[1,1,0] op_sel_hi:[1,0,1] neg_lo:[1,0,0]
    s_add_u32 m0, s46, 82944
    s_add_u32 s45, s47, 1161216
    buffer_load_dwordx4 v114, s[24:27], s45 offen lds
    v_cos_f32 v92, v89
    v_cvt_pk_f16_f32 v86, v58, v59
    v_sin_f32 v93, v89
    v_pk_mul_f32 v[60:61], v[48:49], v[60:61] op_sel_hi:[0,1]
    v_exp_f32 v88, v88
    v_cvt_pk_f16_f32 v82, v60, v61
    s_waitcnt lgkmcnt(0)
    ds_read_b128 v[32:35], v42 offset:416
    v_pk_fma_f32 v[48:49], v[36:37], v[40:41], v[62:63] op_sel_hi:[1,0,1]
    v_pk_fma_f32 v[50:51], v[36:37], v[40:41], v[54:55] op_sel:[0,1,0] op_sel_hi:[1,1,1]
    v_fract_f32 v49, v49
    v_cos_f32 v58, v51
    v_pk_mul_f32 v[60:61], v[30:31], v[92:93] op_sel_hi:[0,1]
    v_sin_f32 v59, v51
    v_pk_mul_f32 v[94:95], v[90:91], v[94:95] op_sel_hi:[0,1] neg_hi:[1,0]
    v_exp_f32 v50, v50
    v_pk_fma_f32 v[60:61], v[30:31], v[92:93], v[60:61] op_sel:[1,1,0] op_sel_hi:[1,0,1] neg_lo:[1,0,0]
    s_add_u32 m0, s46, 83968
    s_add_u32 s45, s47, 1175552
    buffer_load_dwordx4 v114, s[24:27], s45 offen lds
    v_cos_f32 v56, v49
    v_cvt_pk_f16_f32 v87, v94, v95
    v_sin_f32 v57, v49
    v_pk_mul_f32 v[60:61], v[88:89], v[60:61] op_sel_hi:[0,1]
    v_exp_f32 v48, v48
    v_cvt_pk_f16_f32 v83, v60, v61
    s_nop 1
    v_mfma_f32_32x32x16_f16 v[64:79], v[80:83], v[84:87], v[64:79]
    s_waitcnt lgkmcnt(0)
    ds_read_b128 v[28:31], v42 offset:448
    v_pk_fma_f32 v[88:89], v[32:33], v[40:41], v[62:63] op_sel_hi:[1,0,1]
    v_pk_fma_f32 v[90:91], v[32:33], v[40:41], v[54:55] op_sel:[0,1,0] op_sel_hi:[1,1,1]
    v_fract_f32 v89, v89
    v_cos_f32 v94, v91
    v_pk_mul_f32 v[60:61], v[38:39], v[56:57] op_sel_hi:[0,1]
    v_sin_f32 v95, v91
    v_pk_mul_f32 v[58:59], v[50:51], v[58:59] op_sel_hi:[0,1] neg_hi:[1,0]
    v_exp_f32 v90, v90
    v_pk_fma_f32 v[60:61], v[38:39], v[56:57], v[60:61] op_sel:[1,1,0] op_sel_hi:[1,0,1] neg_lo:[1,0,0]
    s_add_u32 m0, s46, 84992
    s_add_u32 s45, s47, 1189888
    buffer_load_dwordx4 v114, s[24:27], s45 offen lds
    v_cos_f32 v92, v89
    v_cvt_pk_f16_f32 v84, v58, v59
    v_sin_f32 v93, v89
    v_pk_mul_f32 v[60:61], v[48:49], v[60:61] op_sel_hi:[0,1]
    v_exp_f32 v88, v88
    v_cvt_pk_f16_f32 v80, v60, v61
    s_waitcnt lgkmcnt(0)
    ds_read_b128 v[36:39], v42 offset:480
    v_pk_fma_f32 v[48:49], v[28:29], v[40:41], v[62:63] op_sel_hi:[1,0,1]
    v_pk_fma_f32 v[50:51], v[28:29], v[40:41], v[54:55] op_sel:[0,1,0] op_sel_hi:[1,1,1]
    v_fract_f32 v49, v49
    v_cos_f32 v58, v51
    v_pk_mul_f32 v[60:61], v[34:35], v[92:93] op_sel_hi:[0,1]
    v_sin_f32 v59, v51
    v_pk_mul_f32 v[94:95], v[90:91], v[94:95] op_sel_hi:[0,1] neg_hi:[1,0]
    v_exp_f32 v50, v50
    v_pk_fma_f32 v[60:61], v[34:35], v[92:93], v[60:61] op_sel:[1,1,0] op_sel_hi:[1,0,1] neg_lo:[1,0,0]
    s_add_u32 m0, s46, 98304
    s_add_u32 s45, s47, 1376256
    buffer_load_dwordx4 v114, s[24:27], s45 offen lds
    v_cos_f32 v56, v49
    v_cvt_pk_f16_f32 v85, v94, v95
    v_sin_f32 v57, v49
    v_pk_mul_f32 v[60:61], v[88:89], v[60:61] op_sel_hi:[0,1]
    v_exp_f32 v48, v48
    v_cvt_pk_f16_f32 v81, v60, v61
    s_waitcnt lgkmcnt(0)
    ds_read_b128 v[32:35], v42 offset:512
    v_pk_fma_f32 v[88:89], v[36:37], v[40:41], v[62:63] op_sel_hi:[1,0,1]
    v_pk_fma_f32 v[90:91], v[36:37], v[40:41], v[54:55] op_sel:[0,1,0] op_sel_hi:[1,1,1]
    v_fract_f32 v89, v89
    v_cos_f32 v94, v91
    v_pk_mul_f32 v[60:61], v[30:31], v[56:57] op_sel_hi:[0,1]
    v_sin_f32 v95, v91
    v_pk_mul_f32 v[58:59], v[50:51], v[58:59] op_sel_hi:[0,1] neg_hi:[1,0]
    v_exp_f32 v90, v90
    v_pk_fma_f32 v[60:61], v[30:31], v[56:57], v[60:61] op_sel:[1,1,0] op_sel_hi:[1,0,1] neg_lo:[1,0,0]
    s_add_u32 m0, s46, 99328
    s_add_u32 s45, s47, 1390592
    buffer_load_dwordx4 v114, s[24:27], s45 offen lds
    v_cos_f32 v92, v89
    v_cvt_pk_f16_f32 v86, v58, v59
    v_sin_f32 v93, v89
    v_pk_mul_f32 v[60:61], v[48:49], v[60:61] op_sel_hi:[0,1]
    v_exp_f32 v88, v88
    v_cvt_pk_f16_f32 v82, v60, v61
    s_waitcnt lgkmcnt(0)
    ds_read_b128 v[28:31], v42 offset:544
    v_pk_fma_f32 v[48:49], v[32:33], v[40:41], v[62:63] op_sel_hi:[1,0,1]
    v_pk_fma_f32 v[50:51], v[32:33], v[40:41], v[54:55] op_sel:[0,1,0] op_sel_hi:[1,1,1]
    v_fract_f32 v49, v49
    v_cos_f32 v58, v51
    v_pk_mul_f32 v[60:61], v[38:39], v[92:93] op_sel_hi:[0,1]
    v_sin_f32 v59, v51
    v_pk_mul_f32 v[94:95], v[90:91], v[94:95] op_sel_hi:[0,1] neg_hi:[1,0]
    v_exp_f32 v50, v50
    v_pk_fma_f32 v[60:61], v[38:39], v[92:93], v[60:61] op_sel:[1,1,0] op_sel_hi:[1,0,1] neg_lo:[1,0,0]
    s_add_u32 m0, s46, 100352
    s_add_u32 s45, s47, 1404928
    buffer_load_dwordx4 v114, s[24:27], s45 offen lds
    v_cos_f32 v56, v49
    v_cvt_pk_f16_f32 v87, v94, v95
    v_sin_f32 v57, v49
    v_pk_mul_f32 v[60:61], v[88:89], v[60:61] op_sel_hi:[0,1]
    v_exp_f32 v48, v48
    v_cvt_pk_f16_f32 v83, v60, v61
    s_nop 1
    v_mfma_f32_32x32x16_f16 v[64:79], v[80:83], v[84:87], v[64:79]
    s_waitcnt lgkmcnt(0)
    ds_read_b128 v[36:39], v42 offset:576
    v_pk_fma_f32 v[88:89], v[28:29], v[40:41], v[62:63] op_sel_hi:[1,0,1]
    v_pk_fma_f32 v[90:91], v[28:29], v[40:41], v[54:55] op_sel:[0,1,0] op_sel_hi:[1,1,1]
    v_fract_f32 v89, v89
    v_cos_f32 v94, v91
    v_pk_mul_f32 v[60:61], v[34:35], v[56:57] op_sel_hi:[0,1]
    v_sin_f32 v95, v91
    v_pk_mul_f32 v[58:59], v[50:51], v[58:59] op_sel_hi:[0,1] neg_hi:[1,0]
    v_exp_f32 v90, v90
    v_pk_fma_f32 v[60:61], v[34:35], v[56:57], v[60:61] op_sel:[1,1,0] op_sel_hi:[1,0,1] neg_lo:[1,0,0]
    s_add_u32 m0, s46, 101376
    s_add_u32 s45, s47, 1419264
    buffer_load_dwordx4 v114, s[24:27], s45 offen lds
    v_cos_f32 v92, v89
    v_cvt_pk_f16_f32 v84, v58, v59
    v_sin_f32 v93, v89
    v_pk_mul_f32 v[60:61], v[48:49], v[60:61] op_sel_hi:[0,1]
    v_exp_f32 v88, v88
    v_cvt_pk_f16_f32 v80, v60, v61
    s_waitcnt lgkmcnt(0)
    ds_read_b128 v[32:35], v42 offset:608
    v_pk_fma_f32 v[48:49], v[36:37], v[40:41], v[62:63] op_sel_hi:[1,0,1]
    v_pk_fma_f32 v[50:51], v[36:37], v[40:41], v[54:55] op_sel:[0,1,0] op_sel_hi:[1,1,1]
    v_fract_f32 v49, v49
    v_cos_f32 v58, v51
    v_pk_mul_f32 v[60:61], v[30:31], v[92:93] op_sel_hi:[0,1]
    v_sin_f32 v59, v51
    v_pk_mul_f32 v[94:95], v[90:91], v[94:95] op_sel_hi:[0,1] neg_hi:[1,0]
    v_exp_f32 v50, v50
    v_pk_fma_f32 v[60:61], v[30:31], v[92:93], v[60:61] op_sel:[1,1,0] op_sel_hi:[1,0,1] neg_lo:[1,0,0]
    s_add_u32 m0, s46, 114688
    s_add_u32 s45, s47, 1605632
    buffer_load_dwordx4 v114, s[24:27], s45 offen lds
    v_cos_f32 v56, v49
    v_cvt_pk_f16_f32 v85, v94, v95
    v_sin_f32 v57, v49
    v_pk_mul_f32 v[60:61], v[88:89], v[60:61] op_sel_hi:[0,1]
    v_exp_f32 v48, v48
    v_cvt_pk_f16_f32 v81, v60, v61
    s_waitcnt lgkmcnt(0)
    ds_read_b128 v[28:31], v42 offset:640
    v_pk_fma_f32 v[88:89], v[32:33], v[40:41], v[62:63] op_sel_hi:[1,0,1]
    v_pk_fma_f32 v[90:91], v[32:33], v[40:41], v[54:55] op_sel:[0,1,0] op_sel_hi:[1,1,1]
    v_fract_f32 v89, v89
    v_cos_f32 v94, v91
    v_pk_mul_f32 v[60:61], v[38:39], v[56:57] op_sel_hi:[0,1]
    v_sin_f32 v95, v91
    v_pk_mul_f32 v[58:59], v[50:51], v[58:59] op_sel_hi:[0,1] neg_hi:[1,0]
    v_exp_f32 v90, v90
    v_pk_fma_f32 v[60:61], v[38:39], v[56:57], v[60:61] op_sel:[1,1,0] op_sel_hi:[1,0,1] neg_lo:[1,0,0]
    s_add_u32 m0, s46, 115712
    s_add_u32 s45, s47, 1619968
    buffer_load_dwordx4 v114, s[24:27], s45 offen lds
    v_cos_f32 v92, v89
    v_cvt_pk_f16_f32 v86, v58, v59
    v_sin_f32 v93, v89
    v_pk_mul_f32 v[60:61], v[48:49], v[60:61] op_sel_hi:[0,1]
    v_exp_f32 v88, v88
    v_cvt_pk_f16_f32 v82, v60, v61
    s_waitcnt lgkmcnt(0)
    ds_read_b128 v[36:39], v42 offset:672
    v_pk_fma_f32 v[48:49], v[28:29], v[40:41], v[62:63] op_sel_hi:[1,0,1]
    v_pk_fma_f32 v[50:51], v[28:29], v[40:41], v[54:55] op_sel:[0,1,0] op_sel_hi:[1,1,1]
    v_fract_f32 v49, v49
    v_cos_f32 v58, v51
    v_pk_mul_f32 v[60:61], v[34:35], v[92:93] op_sel_hi:[0,1]
    v_sin_f32 v59, v51
    v_pk_mul_f32 v[94:95], v[90:91], v[94:95] op_sel_hi:[0,1] neg_hi:[1,0]
    v_exp_f32 v50, v50
    v_pk_fma_f32 v[60:61], v[34:35], v[92:93], v[60:61] op_sel:[1,1,0] op_sel_hi:[1,0,1] neg_lo:[1,0,0]
    s_add_u32 m0, s46, 116736
    s_add_u32 s45, s47, 1634304
    buffer_load_dwordx4 v114, s[24:27], s45 offen lds
    v_cos_f32 v56, v49
    v_cvt_pk_f16_f32 v87, v94, v95
    v_sin_f32 v57, v49
    v_pk_mul_f32 v[60:61], v[88:89], v[60:61] op_sel_hi:[0,1]
    v_exp_f32 v48, v48
    v_cvt_pk_f16_f32 v83, v60, v61
    s_nop 1
    v_mfma_f32_32x32x16_f16 v[64:79], v[80:83], v[84:87], v[64:79]
    s_waitcnt lgkmcnt(0)
    ds_read_b128 v[32:35], v42 offset:704
    v_pk_fma_f32 v[88:89], v[36:37], v[40:41], v[62:63] op_sel_hi:[1,0,1]
    v_pk_fma_f32 v[90:91], v[36:37], v[40:41], v[54:55] op_sel:[0,1,0] op_sel_hi:[1,1,1]
    v_fract_f32 v89, v89
    v_cos_f32 v94, v91
    v_pk_mul_f32 v[60:61], v[30:31], v[56:57] op_sel_hi:[0,1]
    v_sin_f32 v95, v91
    v_pk_mul_f32 v[58:59], v[50:51], v[58:59] op_sel_hi:[0,1] neg_hi:[1,0]
    v_exp_f32 v90, v90
    v_pk_fma_f32 v[60:61], v[30:31], v[56:57], v[60:61] op_sel:[1,1,0] op_sel_hi:[1,0,1] neg_lo:[1,0,0]
    s_add_u32 m0, s46, 117760
    s_add_u32 s45, s47, 1648640
    buffer_load_dwordx4 v114, s[24:27], s45 offen lds
    v_cos_f32 v92, v89
    v_cvt_pk_f16_f32 v84, v58, v59
    v_sin_f32 v93, v89
    v_pk_mul_f32 v[60:61], v[48:49], v[60:61] op_sel_hi:[0,1]
    v_exp_f32 v88, v88
    v_cvt_pk_f16_f32 v80, v60, v61
    s_waitcnt lgkmcnt(0)
    ds_read_b128 v[28:31], v42 offset:736
    v_pk_fma_f32 v[48:49], v[32:33], v[40:41], v[62:63] op_sel_hi:[1,0,1]
    v_pk_fma_f32 v[50:51], v[32:33], v[40:41], v[54:55] op_sel:[0,1,0] op_sel_hi:[1,1,1]
    v_fract_f32 v49, v49
    v_cos_f32 v58, v51
    v_pk_mul_f32 v[60:61], v[38:39], v[92:93] op_sel_hi:[0,1]
    v_sin_f32 v59, v51
    v_pk_mul_f32 v[94:95], v[90:91], v[94:95] op_sel_hi:[0,1] neg_hi:[1,0]
    v_exp_f32 v50, v50
    v_pk_fma_f32 v[60:61], v[38:39], v[92:93], v[60:61] op_sel:[1,1,0] op_sel_hi:[1,0,1] neg_lo:[1,0,0]
    v_cos_f32 v56, v49
    v_cvt_pk_f16_f32 v85, v94, v95
    v_sin_f32 v57, v49
    v_pk_mul_f32 v[60:61], v[88:89], v[60:61] op_sel_hi:[0,1]
    v_exp_f32 v48, v48
    v_cvt_pk_f16_f32 v81, v60, v61
    s_waitcnt lgkmcnt(0)
    ds_read_b128 v[36:39], v42 offset:768
    v_pk_fma_f32 v[88:89], v[28:29], v[40:41], v[62:63] op_sel_hi:[1,0,1]
    v_pk_fma_f32 v[90:91], v[28:29], v[40:41], v[54:55] op_sel:[0,1,0] op_sel_hi:[1,1,1]
    v_fract_f32 v89, v89
    v_cos_f32 v94, v91
    v_pk_mul_f32 v[60:61], v[34:35], v[56:57] op_sel_hi:[0,1]
    v_sin_f32 v95, v91
    v_pk_mul_f32 v[58:59], v[50:51], v[58:59] op_sel_hi:[0,1] neg_hi:[1,0]
    v_exp_f32 v90, v90
    v_pk_fma_f32 v[60:61], v[34:35], v[56:57], v[60:61] op_sel:[1,1,0] op_sel_hi:[1,0,1] neg_lo:[1,0,0]
    v_cos_f32 v92, v89
    v_cvt_pk_f16_f32 v86, v58, v59
    v_sin_f32 v93, v89
    v_pk_mul_f32 v[60:61], v[48:49], v[60:61] op_sel_hi:[0,1]
    v_exp_f32 v88, v88
    v_cvt_pk_f16_f32 v82, v60, v61
    s_waitcnt lgkmcnt(0)
    ds_read_b128 v[32:35], v42 offset:800
    v_pk_fma_f32 v[48:49], v[36:37], v[40:41], v[62:63] op_sel_hi:[1,0,1]
    v_pk_fma_f32 v[50:51], v[36:37], v[40:41], v[54:55] op_sel:[0,1,0] op_sel_hi:[1,1,1]
    v_fract_f32 v49, v49
    v_cos_f32 v58, v51
    v_pk_mul_f32 v[60:61], v[30:31], v[92:93] op_sel_hi:[0,1]
    v_sin_f32 v59, v51
    v_pk_mul_f32 v[94:95], v[90:91], v[94:95] op_sel_hi:[0,1] neg_hi:[1,0]
    v_exp_f32 v50, v50
    v_pk_fma_f32 v[60:61], v[30:31], v[92:93], v[60:61] op_sel:[1,1,0] op_sel_hi:[1,0,1] neg_lo:[1,0,0]
    v_cos_f32 v56, v49
    v_cvt_pk_f16_f32 v87, v94, v95
    v_sin_f32 v57, v49
    v_pk_mul_f32 v[60:61], v[88:89], v[60:61] op_sel_hi:[0,1]
    v_exp_f32 v48, v48
    v_cvt_pk_f16_f32 v83, v60, v61
    s_nop 1
    v_mfma_f32_32x32x16_f16 v[64:79], v[80:83], v[84:87], v[64:79]
    s_waitcnt lgkmcnt(0)
    ds_read_b128 v[28:31], v42 offset:832
    v_pk_fma_f32 v[88:89], v[32:33], v[40:41], v[62:63] op_sel_hi:[1,0,1]
    v_pk_fma_f32 v[90:91], v[32:33], v[40:41], v[54:55] op_sel:[0,1,0] op_sel_hi:[1,1,1]
    v_fract_f32 v89, v89
    v_cos_f32 v94, v91
    v_pk_mul_f32 v[60:61], v[38:39], v[56:57] op_sel_hi:[0,1]
    v_sin_f32 v95, v91
    v_pk_mul_f32 v[58:59], v[50:51], v[58:59] op_sel_hi:[0,1] neg_hi:[1,0]
    v_exp_f32 v90, v90
    v_pk_fma_f32 v[60:61], v[38:39], v[56:57], v[60:61] op_sel:[1,1,0] op_sel_hi:[1,0,1] neg_lo:[1,0,0]
    v_cos_f32 v92, v89
    v_cvt_pk_f16_f32 v84, v58, v59
    v_sin_f32 v93, v89
    v_pk_mul_f32 v[60:61], v[48:49], v[60:61] op_sel_hi:[0,1]
    v_exp_f32 v88, v88
    v_cvt_pk_f16_f32 v80, v60, v61
    s_waitcnt lgkmcnt(0)
    ds_read_b128 v[36:39], v42 offset:864
    v_pk_fma_f32 v[48:49], v[28:29], v[40:41], v[62:63] op_sel_hi:[1,0,1]
    v_pk_fma_f32 v[50:51], v[28:29], v[40:41], v[54:55] op_sel:[0,1,0] op_sel_hi:[1,1,1]
    v_fract_f32 v49, v49
    v_cos_f32 v58, v51
    v_pk_mul_f32 v[60:61], v[34:35], v[92:93] op_sel_hi:[0,1]
    v_sin_f32 v59, v51
    v_pk_mul_f32 v[94:95], v[90:91], v[94:95] op_sel_hi:[0,1] neg_hi:[1,0]
    v_exp_f32 v50, v50
    v_pk_fma_f32 v[60:61], v[34:35], v[92:93], v[60:61] op_sel:[1,1,0] op_sel_hi:[1,0,1] neg_lo:[1,0,0]
    v_cos_f32 v56, v49
    v_cvt_pk_f16_f32 v85, v94, v95
    v_sin_f32 v57, v49
    v_pk_mul_f32 v[60:61], v[88:89], v[60:61] op_sel_hi:[0,1]
    v_exp_f32 v48, v48
    v_cvt_pk_f16_f32 v81, v60, v61
    s_waitcnt lgkmcnt(0)
    ds_read_b128 v[32:35], v42 offset:896
    v_pk_fma_f32 v[88:89], v[36:37], v[40:41], v[62:63] op_sel_hi:[1,0,1]
    v_pk_fma_f32 v[90:91], v[36:37], v[40:41], v[54:55] op_sel:[0,1,0] op_sel_hi:[1,1,1]
    v_fract_f32 v89, v89
    v_cos_f32 v94, v91
    v_pk_mul_f32 v[60:61], v[30:31], v[56:57] op_sel_hi:[0,1]
    v_sin_f32 v95, v91
    v_pk_mul_f32 v[58:59], v[50:51], v[58:59] op_sel_hi:[0,1] neg_hi:[1,0]
    v_exp_f32 v90, v90
    v_pk_fma_f32 v[60:61], v[30:31], v[56:57], v[60:61] op_sel:[1,1,0] op_sel_hi:[1,0,1] neg_lo:[1,0,0]
    v_cos_f32 v92, v89
    v_cvt_pk_f16_f32 v86, v58, v59
    v_sin_f32 v93, v89
    v_pk_mul_f32 v[60:61], v[48:49], v[60:61] op_sel_hi:[0,1]
    v_exp_f32 v88, v88
    v_cvt_pk_f16_f32 v82, v60, v61
    s_waitcnt lgkmcnt(0)
    ds_read_b128 v[28:31], v42 offset:928
    v_pk_fma_f32 v[48:49], v[32:33], v[40:41], v[62:63] op_sel_hi:[1,0,1]
    v_pk_fma_f32 v[50:51], v[32:33], v[40:41], v[54:55] op_sel:[0,1,0] op_sel_hi:[1,1,1]
    v_fract_f32 v49, v49
    v_cos_f32 v58, v51
    v_pk_mul_f32 v[60:61], v[38:39], v[92:93] op_sel_hi:[0,1]
    v_sin_f32 v59, v51
    v_pk_mul_f32 v[94:95], v[90:91], v[94:95] op_sel_hi:[0,1] neg_hi:[1,0]
    v_exp_f32 v50, v50
    v_pk_fma_f32 v[60:61], v[38:39], v[92:93], v[60:61] op_sel:[1,1,0] op_sel_hi:[1,0,1] neg_lo:[1,0,0]
    v_cos_f32 v56, v49
    v_cvt_pk_f16_f32 v87, v94, v95
    v_sin_f32 v57, v49
    v_pk_mul_f32 v[60:61], v[88:89], v[60:61] op_sel_hi:[0,1]
    v_exp_f32 v48, v48
    v_cvt_pk_f16_f32 v83, v60, v61
    s_nop 1
    v_mfma_f32_32x32x16_f16 v[64:79], v[80:83], v[84:87], v[64:79]
    s_waitcnt lgkmcnt(0)
    ds_read_b128 v[36:39], v42 offset:960
    v_pk_fma_f32 v[88:89], v[28:29], v[40:41], v[62:63] op_sel_hi:[1,0,1]
    v_pk_fma_f32 v[90:91], v[28:29], v[40:41], v[54:55] op_sel:[0,1,0] op_sel_hi:[1,1,1]
    v_fract_f32 v89, v89
    v_cos_f32 v94, v91
    v_pk_mul_f32 v[60:61], v[34:35], v[56:57] op_sel_hi:[0,1]
    v_sin_f32 v95, v91
    v_pk_mul_f32 v[58:59], v[50:51], v[58:59] op_sel_hi:[0,1] neg_hi:[1,0]
    v_exp_f32 v90, v90
    v_pk_fma_f32 v[60:61], v[34:35], v[56:57], v[60:61] op_sel:[1,1,0] op_sel_hi:[1,0,1] neg_lo:[1,0,0]
    v_cos_f32 v92, v89
    v_cvt_pk_f16_f32 v84, v58, v59
    v_sin_f32 v93, v89
    v_pk_mul_f32 v[60:61], v[48:49], v[60:61] op_sel_hi:[0,1]
    v_exp_f32 v88, v88
    v_cvt_pk_f16_f32 v80, v60, v61
    s_waitcnt lgkmcnt(0)
    ds_read_b128 v[32:35], v42 offset:992
    v_pk_fma_f32 v[48:49], v[36:37], v[40:41], v[62:63] op_sel_hi:[1,0,1]
    v_pk_fma_f32 v[50:51], v[36:37], v[40:41], v[54:55] op_sel:[0,1,0] op_sel_hi:[1,1,1]
    v_fract_f32 v49, v49
    v_cos_f32 v58, v51
    v_pk_mul_f32 v[60:61], v[30:31], v[92:93] op_sel_hi:[0,1]
    v_sin_f32 v59, v51
    v_pk_mul_f32 v[94:95], v[90:91], v[94:95] op_sel_hi:[0,1] neg_hi:[1,0]
    v_exp_f32 v50, v50
    v_pk_fma_f32 v[60:61], v[30:31], v[92:93], v[60:61] op_sel:[1,1,0] op_sel_hi:[1,0,1] neg_lo:[1,0,0]
    v_cos_f32 v56, v49
    v_cvt_pk_f16_f32 v85, v94, v95
    v_sin_f32 v57, v49
    v_pk_mul_f32 v[60:61], v[88:89], v[60:61] op_sel_hi:[0,1]
    v_exp_f32 v48, v48
    v_cvt_pk_f16_f32 v81, v60, v61
    s_waitcnt lgkmcnt(0)
    v_pk_fma_f32 v[88:89], v[32:33], v[40:41], v[62:63] op_sel_hi:[1,0,1]
    v_pk_fma_f32 v[90:91], v[32:33], v[40:41], v[54:55] op_sel:[0,1,0] op_sel_hi:[1,1,1]
    v_fract_f32 v89, v89
    v_cos_f32 v94, v91
    v_pk_mul_f32 v[60:61], v[38:39], v[56:57] op_sel_hi:[0,1]
    v_sin_f32 v95, v91
    v_pk_mul_f32 v[58:59], v[50:51], v[58:59] op_sel_hi:[0,1] neg_hi:[1,0]
    v_exp_f32 v90, v90
    v_pk_fma_f32 v[60:61], v[38:39], v[56:57], v[60:61] op_sel:[1,1,0] op_sel_hi:[1,0,1] neg_lo:[1,0,0]
    v_cos_f32 v92, v89
    v_cvt_pk_f16_f32 v86, v58, v59
    v_sin_f32 v93, v89
    v_pk_mul_f32 v[60:61], v[48:49], v[60:61] op_sel_hi:[0,1]
    v_exp_f32 v88, v88
    v_cvt_pk_f16_f32 v82, v60, v61
    v_pk_mul_f32 v[60:61], v[34:35], v[92:93] op_sel_hi:[0,1]
    v_pk_mul_f32 v[94:95], v[90:91], v[94:95] op_sel_hi:[0,1] neg_hi:[1,0]
    v_pk_fma_f32 v[60:61], v[34:35], v[92:93], v[60:61] op_sel:[1,1,0] op_sel_hi:[1,0,1] neg_lo:[1,0,0]
    v_cvt_pk_f16_f32 v87, v94, v95
    v_pk_mul_f32 v[60:61], v[88:89], v[60:61] op_sel_hi:[0,1]
    v_cvt_pk_f16_f32 v83, v60, v61
    s_nop 1
    v_mfma_f32_32x32x16_f16 v[64:79], v[80:83], v[84:87], v[64:79]
    v_bfe_u32 v28, v0, 5, 1
    v_mov_b32 v114, v45
    v_mul_u32_u24 v47, 3584, v1
    v_add_u32 v47, 135168, v47
    v_lshl_add_u32 v43, v6, 6, v47
    v_lshl_add_u32 v43, v28, 4, v43
    v_lshlrev_b32 v44, 4, v6
    v_add_u32 v44, 2048, v44
    v_add_u32 v45, 8, v44
    v_lshlrev_b32 v46, 3, v6
    v_add_u32 v48, 2560, v46
    v_add_u32 v49, 2816, v46
    v_cmp_eq_u32 vcc, 1, v28
    v_add_u32 v46, 3072, v46
    v_lshl_add_u32 v46, v28, 2, v46
    v_cndmask_b32 v44, v44, v48, vcc
    v_cndmask_b32 v45, v45, v49, vcc
    v_add_u32 v44, v44, v47
    v_add_u32 v45, v45, v47
    v_add_u32 v46, v46, v47
    ds_write_b128 v43, v[64:67]
    ds_write_b128 v43, v[68:71] offset:32
    ds_write_b64 v44, v[72:73]
    ds_write_b64 v45, v[74:75]
    ds_write_b32 v46, v76
    v_mov_b32 v20, 0
    v_mov_b32 v21, 0
    v_mov_b32 v22, 0
    v_mov_b32 v23, 0
    v_bfe_u32 v24, v0, 7, 1
    v_mul_u32_u24 v24, 4112, v24
    v_add_u32 v24, 153600, v24
    ds_write_b128 v24, v[20:23]
    s_lshl_b32 s50, s34, 1
    s_and_b32 s58, s3, 1
    s_add_u32 s50, s50, s58
    s_xor_b32 s35, s50, 1
    s_mul_i32 s58, s3, 28672
    s_add_u32 s58, s58, 0x1840000
    s_mul_i32 s50, s50, 114688
    s_add_u32 s50, s50, s58
    s_mul_i32 s35, s35, 114688
    s_add_u32 s35, s35, s58
    s_lshl_b32 s51, s31, 4
    s_add_u32 s51, s51, s32
    s_lshl_b32 s51, s51, 6
    s_add_u32 s51, s51, 0x180e000
    s_cmp_lg_u32 s3, 0
    s_cbranch_scc1 L_b1_done
    s_mov_b32 s40, s6
    s_and_b32 s41, s7, 0xffff
    s_mov_b32 s42, 256
    s_mov_b32 s43, 0x20000
    v_lshlrev_b32 v118, 6, v0
    s_mov_b64 exec, 0xf
L_b1:
    s_sub_u32 s30, s30, 1
    s_cbranch_scc0 L_b1_c
    s_mov_b32 s30, 0
    s_branch L_b1_x
L_b1_c:
    buffer_load_dword v119, v118, s[40:43], 0 offen sc1
    s_waitcnt vmcnt(0)
    v_cmpx_gt_u32 vcc, 64, v119
    s_cbranch_execnz L_b1
L_b1_x:
    s_mov_b64 exec, -1
L_b1_done:
    s_waitcnt vmcnt(0) lgkmcnt(0)
    s_barrier
    v_lshlrev_b32 v4, 5, v0
    v_lshlrev_b32 v3, 13, v0
    s_lshl_b32 s40, s2, 5
    s_mov_b32 s41, 0x1800000
    buffer_load_dwordx4 v[16:19], v4, s[8:11], s41 offen sc1
    buffer_load_dwordx4 v[20:23], v4, s[8:11], s41 offen offset:16 sc1
    buffer_load_dwordx4 v[32:35], v3, s[8:11], s40 offen sc1
    buffer_load_dwordx4 v[36:39], v3, s[8:11], s40 offen offset:16 sc1

    ds_read_b32 v64, v104 offset:4096
    ds_read_b32 v65, v105 offset:4096
    ds_read_b32 v66, v106 offset:4096
    ds_read_b32 v67, v107 offset:4096
    ds_read_b32 v68, v108 offset:4096
    ds_read_b32 v69, v109 offset:4096
    ds_read_b32 v70, v110 offset:4096
    ds_read_b32 v71, v111 offset:4096
    ds_read_b32 v72, v104 offset:7680
    ds_read_b32 v73, v105 offset:7680
    ds_read_b32 v74, v106 offset:7680
    ds_read_b32 v75, v107 offset:7680
    ds_read_b32 v76, v108 offset:7680
    ds_read_b32 v77, v109 offset:7680
    ds_read_b32 v78, v110 offset:7680
    ds_read_b32 v79, v111 offset:7680
    ds_read_b32 v80, v104 offset:11264
    ds_read_b32 v81, v105 offset:11264
    ds_read_b32 v82, v106 offset:11264
    ds_read_b32 v83, v107 offset:11264
    ds_read_b32 v84, v108 offset:11264
    ds_read_b32 v85, v109 offset:11264
    ds_read_b32 v86, v110 offset:11264
    ds_read_b32 v87, v111 offset:11264
    ds_read_b32 v88, v104 offset:14848
    ds_read_b32 v89, v105 offset:14848
    ds_read_b32 v90, v106 offset:14848
    ds_read_b32 v91, v107 offset:14848
    ds_read_b32 v92, v108 offset:14848
    ds_read_b32 v93, v109 offset:14848
    ds_read_b32 v94, v110 offset:14848
    ds_read_b32 v95, v111 offset:14848
    v_lshlrev_b32 v9, 1, v0
    v_add_u32 v9, 153600, v9
    s_waitcnt lgkmcnt(15)
    v_pk_add_f32 v[64:65], v[64:65], v[72:73]
    v_pk_add_f32 v[66:67], v[66:67], v[74:75]
    v_pk_add_f32 v[68:69], v[68:69], v[76:77]
    v_pk_add_f32 v[70:71], v[70:71], v[78:79]
    v_pk_mul_f32 v[64:65], v[64:65], v[112:113] op_sel:[0,0] op_sel_hi:[1,0]
    v_pk_mul_f32 v[66:67], v[66:67], v[112:113] op_sel:[0,0] op_sel_hi:[1,0]
    v_pk_mul_f32 v[68:69], v[68:69], v[112:113] op_sel:[0,0] op_sel_hi:[1,0]
    v_pk_mul_f32 v[70:71], v[70:71], v[112:113] op_sel:[0,0] op_sel_hi:[1,0]
    s_cmp_lg_u32 s48, 0
    s_cbranch_scc1 L_gr0
L_gr0r:
    v_cvt_pk_bf16_f32 v40, v64, v65
    v_cvt_pk_bf16_f32 v41, v66, v67
    v_cvt_pk_bf16_f32 v42, v68, v69
    v_cvt_pk_bf16_f32 v43, v70, v71
    ds_write_b16 v9, v40 offset:16
    ds_write_b16_d16_hi v9, v40 offset:528
    ds_write_b16 v9, v41 offset:1040
    ds_write_b16_d16_hi v9, v41 offset:1552
    ds_write_b16 v9, v42 offset:2064
    ds_write_b16_d16_hi v9, v42 offset:2576
    ds_write_b16 v9, v43 offset:3088
    ds_write_b16_d16_hi v9, v43 offset:3600
    s_waitcnt lgkmcnt(8)
    ds_read_b64_tr_b16 v[124:125], v114 offset:0
    ds_read_b64_tr_b16 v[126:127], v114 offset:1024
    ds_read_b64_tr_b16 v[128:129], v114 offset:4096
    ds_read_b64_tr_b16 v[130:131], v114 offset:5120
    ds_read_b64_tr_b16 v[132:133], v114 offset:8192
    ds_read_b64_tr_b16 v[134:135], v114 offset:9216
    ds_read_b64_tr_b16 v[136:137], v114 offset:12288
    ds_read_b64_tr_b16 v[138:139], v114 offset:13312
    ds_read_b64_tr_b16 v[140:141], v114 offset:16384
    ds_read_b64_tr_b16 v[142:143], v114 offset:17408
    ds_read_b64_tr_b16 v[144:145], v114 offset:20480
    ds_read_b64_tr_b16 v[146:147], v114 offset:21504
    ds_read_b64_tr_b16 v[148:149], v114 offset:24576
    ds_read_b64_tr_b16 v[150:151], v114 offset:25600
    ds_read_b64_tr_b16 v[152:153], v114 offset:28672
    ds_read_b64_tr_b16 v[154:155], v114 offset:29696
    ds_read_b64_tr_b16 v[156:157], v114 offset:32768
    ds_read_b64_tr_b16 v[158:159], v114 offset:33792
    ds_read_b64_tr_b16 v[160:161], v114 offset:36864
    ds_read_b64_tr_b16 v[162:163], v114 offset:37888
    ds_read_b64_tr_b16 v[164:165], v114 offset:40960
    ds_read_b64_tr_b16 v[166:167], v114 offset:41984
    ds_read_b64_tr_b16 v[168:169], v114 offset:45056
    ds_read_b64_tr_b16 v[170:171], v114 offset:46080
    ds_read_b64_tr_b16 v[172:173], v114 offset:49152
    ds_read_b64_tr_b16 v[174:175], v114 offset:50176
    ds_read_b64_tr_b16 v[176:177], v114 offset:53248
    ds_read_b64_tr_b16 v[178:179], v114 offset:54272
    ds_read_b64_tr_b16 v[180:181], v114 offset:57344
    ds_read_b64_tr_b16 v[182:183], v114 offset:58368
    ds_read_b64_tr_b16 v[184:185], v114 offset:61440
    ds_read_b64_tr_b16 v[186:187], v114 offset:62464
    ds_read_b64_tr_b16 v[188:189], v115 offset:0
    ds_read_b64_tr_b16 v[190:191], v115 offset:1024
    ds_read_b64_tr_b16 v[192:193], v115 offset:4096
    ds_read_b64_tr_b16 v[194:195], v115 offset:5120
    ds_read_b64_tr_b16 v[196:197], v115 offset:8192
    ds_read_b64_tr_b16 v[198:199], v115 offset:9216
    ds_read_b64_tr_b16 v[200:201], v115 offset:12288
    ds_read_b64_tr_b16 v[202:203], v115 offset:13312
    ds_read_b64_tr_b16 v[204:205], v115 offset:16384
    ds_read_b64_tr_b16 v[206:207], v115 offset:17408
    ds_read_b64_tr_b16 v[208:209], v115 offset:20480
    ds_read_b64_tr_b16 v[210:211], v115 offset:21504
    ds_read_b64_tr_b16 v[212:213], v115 offset:24576
    ds_read_b64_tr_b16 v[214:215], v115 offset:25600
    ds_read_b64_tr_b16 v[216:217], v115 offset:28672
    ds_read_b64_tr_b16 v[218:219], v115 offset:29696
    ds_read_b64_tr_b16 v[220:221], v115 offset:32768
    ds_read_b64_tr_b16 v[222:223], v115 offset:33792
    ds_read_b64_tr_b16 v[224:225], v115 offset:36864
    ds_read_b64_tr_b16 v[226:227], v115 offset:37888
    ds_read_b64_tr_b16 v[228:229], v115 offset:40960
    ds_read_b64_tr_b16 v[230:231], v115 offset:41984
    ds_read_b64_tr_b16 v[232:233], v115 offset:45056
    ds_read_b64_tr_b16 v[234:235], v115 offset:46080
    ds_read_b64_tr_b16 v[236:237], v115 offset:49152
    ds_read_b64_tr_b16 v[238:239], v115 offset:50176
    ds_read_b64_tr_b16 v[240:241], v115 offset:53248
    ds_read_b64_tr_b16 v[242:243], v115 offset:54272
    ds_read_b64_tr_b16 v[244:245], v115 offset:57344
    ds_read_b64_tr_b16 v[246:247], v115 offset:58368
    ds_read_b64_tr_b16 v[248:249], v115 offset:61440
    ds_read_b64_tr_b16 v[250:251], v115 offset:62464
    v_pk_add_f32 v[80:81], v[80:81], v[88:89]
    v_pk_add_f32 v[82:83], v[82:83], v[90:91]
    v_pk_add_f32 v[84:85], v[84:85], v[92:93]
    v_pk_add_f32 v[86:87], v[86:87], v[94:95]
    v_pk_mul_f32 v[80:81], v[80:81], v[112:113] op_sel:[0,1] op_sel_hi:[1,1]
    v_pk_mul_f32 v[82:83], v[82:83], v[112:113] op_sel:[0,1] op_sel_hi:[1,1]
    v_pk_mul_f32 v[84:85], v[84:85], v[112:113] op_sel:[0,1] op_sel_hi:[1,1]
    v_pk_mul_f32 v[86:87], v[86:87], v[112:113] op_sel:[0,1] op_sel_hi:[1,1]
    s_cmp_lg_u32 s48, 0
    s_cbranch_scc1 L_gr1
L_gr1r:
    v_cvt_pk_bf16_f32 v44, v80, v81
    v_cvt_pk_bf16_f32 v45, v82, v83
    v_cvt_pk_bf16_f32 v46, v84, v85
    v_cvt_pk_bf16_f32 v47, v86, v87
    ds_write_b16 v9, v44 offset:4128
    ds_write_b16_d16_hi v9, v44 offset:4640
    ds_write_b16 v9, v45 offset:5152
    ds_write_b16_d16_hi v9, v45 offset:5664
    ds_write_b16 v9, v46 offset:6176
    ds_write_b16_d16_hi v9, v46 offset:6688
    ds_write_b16 v9, v47 offset:7200
    ds_write_b16_d16_hi v9, v47 offset:7712
    s_waitcnt lgkmcnt(0)
    s_barrier
    s_branch L_cv_ld
L_layer:
    v_lshlrev_b32 v2, 4, v0
    v_lshlrev_b32 v4, 5, v0
    s_mov_b32 s41, 0x1802000
    s_mov_b32 s42, 0x1804000
    s_lshl_b32 s40, s2, 7
    s_add_u32 s40, s40, 0x400000
    v_lshrrev_b32 v3, 2, v0
    v_lshlrev_b32 v3, 15, v3
    v_and_b32 v5, 3, v0
    v_lshl_add_u32 v3, v5, 4, v3
    buffer_load_dwordx4 v[16:19], v4, s[8:11], s41 offen sc1
    buffer_load_dwordx4 v[24:27], v4, s[8:11], s42 offen sc1
    buffer_load_dwordx4 v[20:23], v4, s[8:11], s41 offen offset:16 sc1
    buffer_load_dwordx4 v[28:31], v4, s[8:11], s42 offen offset:16 sc1
    buffer_load_dwordx4 v[32:35], v3, s[8:11], s40 offen sc1
    buffer_load_dwordx4 v[36:39], v3, s[8:11], s40 offen offset:64 sc1
    s_branch L_cv_go
L_cv_ld:
    v_lshlrev_b32 v2, 4, v0
    v_and_b32 v6, 15, v0
    v_bfe_u32 v7, v0, 4, 2
    s_lshr_b32 s43, s3, 1
    s_and_b32 s44, s3, 1
    v_lshrrev_b32 v8, 2, v6
    v_mul_u32_u24 v12, 4160, v8
    v_and_b32 v8, 3, v0
    v_lshl_add_u32 v12, v8, 3, v12
    v_lshlrev_b32 v8, 4, v7
    v_sub_u32 v12, v12, v8
    s_mul_i32 s45, s43, 16640
    s_lshl_b32 s46, s44, 8
    s_add_u32 s45, s45, s46
    s_add_u32 s45, s45, 9272
    v_add_u32 v12, s45, v12
    v_lshlrev_b32 v13, 5, v6
    v_lshl_add_u32 v11, v7, 3, v13
    v_lshl_add_u32 v13, v7, 4, v13
    s_mul_i32 s45, s43, 4608
    s_sub_u32 s47, s45, s46
    s_add_u32 s47, s47, 288
    v_add_u32 v13, s47, v13
    s_lshl_b32 s47, s3, 12
    s_add_u32 s47, s47, 42496
    v_add_u32 v14, s47, v116
    s_xor_b32 s47, s3, 1
    s_lshl_b32 s47, s47, 12
    s_add_u32 s47, s47, 42496
    v_add_u32 v15, s47, v116
    v_and_b32 v8, 1, v7
    v_lshlrev_b32 v10, 9, v8
    v_lshl_add_u32 v10, v6, 5, v10
    v_lshrrev_b32 v8, 1, v7
    v_lshl_add_u32 v10, v8, 4, v10
    s_lshl_b32 s48, s2, 1
    s_add_u32 s48, s48, s43
    s_lshl_b32 s48, s48, 12
    s_lshl_b32 s46, s44, 11
    s_add_u32 s48, s48, s46
    s_add_u32 s48, s48, s36
    s_add_u32 s45, s45, s46
    s_add_u32 s45, s45, 512
    v_add_u32 v9, s45, v11
    s_lshl_b32 s45, s43, 12
    s_add_u32 s45, s45, s46
    s_add_u32 s45, s45, 58880
    v_add_u32 v11, s45, v11
    s_lshl_b32 s49, s28, 16
    s_and_b32 s45, s28, 0xffff0000
    s_cmp_eq_u32 s43, 0
    s_cselect_b32 s49, s49, s45
L_cv_go:
    s_cmp_lg_u32 s29, 0
    s_cbranch_scc1 L_cv_fin
    v_lshlrev_b32 v48, 4, v0
    v_add_u32 v49, 153600, v48
    v_add_u32 v48, 9248, v48
    ds_read_b64 v[56:57], v49 offset:8
    ds_read_b128 v[58:61], v49 offset:16
    ds_read_b64 v[62:63], v49 offset:4120
    ds_read_b128 v[64:67], v49 offset:4128
    v_mov_b32 v68, 0
    v_mov_b32 v69, 0
    v_mov_b32 v70, 0
    v_mov_b32 v71, 0
    v_bfe_u32 v50, v0, 5, 1
    v_mul_u32_u24 v50, 4608, v50
    v_and_b32 v51, 31, v0
    v_lshl_add_u32 v50, v51, 4, v50
    v_add_u32 v50, 0, v50
    ds_write_b128 v50, v[68:71]
    v_bfe_u32 v50, v0, 3, 1
    v_mul_u32_u24 v50, 16640, v50
    v_bfe_u32 v51, v0, 1, 2
    v_mul_u32_u24 v51, 4160, v51
    v_add_u32 v50, v50, v51
    v_and_b32 v51, 1, v0
    v_lshl_add_u32 v50, v51, 4, v50
    v_add_u32 v50, 9216, v50
    ds_write_b128 v50, v[68:71]
    s_waitcnt lgkmcnt(2)
    ds_write_b128 v48, v[58:61] offset:0
    v_alignbit_b32 v72, v57, v56, 16
    v_alignbit_b32 v73, v58, v57, 16
    v_alignbit_b32 v74, v59, v58, 16
    v_alignbit_b32 v75, v60, v59, 16
    ds_write_b128 v48, v[72:75] offset:12480
    v_alignbit_b32 v76, v58, v57, 16
    v_alignbit_b32 v77, v59, v58, 16
    v_alignbit_b32 v78, v60, v59, 16
    v_alignbit_b32 v79, v61, v60, 16
    ds_write_b128 v48, v[76:79] offset:4160
    v_mov_b32 v80, v57
    v_mov_b32 v81, v58
    v_mov_b32 v82, v59
    v_mov_b32 v83, v60
    ds_write_b128 v48, v[80:83] offset:8320
    ds_write_b128 v48, v[64:67] offset:16640
    v_alignbit_b32 v84, v63, v62, 16
    v_alignbit_b32 v85, v64, v63, 16
    v_alignbit_b32 v86, v65, v64, 16
    v_alignbit_b32 v87, v66, v65, 16
    ds_write_b128 v48, v[84:87] offset:29120
    v_alignbit_b32 v88, v64, v63, 16
    v_alignbit_b32 v89, v65, v64, 16
    v_alignbit_b32 v90, v66, v65, 16
    v_alignbit_b32 v91, v67, v66, 16
    ds_write_b128 v48, v[88:91] offset:20800
    v_mov_b32 v92, v63
    v_mov_b32 v93, v64
    v_mov_b32 v94, v65
    v_mov_b32 v95, v66
    ds_write_b128 v48, v[92:95] offset:24960
    buffer_load_dwordx4 a[0:3], v116, s[8:11], s50 offen offset:0 sc1
    buffer_load_dwordx4 a[4:7], v116, s[8:11], s50 offen offset:1024 sc1
    buffer_load_dwordx4 a[8:11], v116, s[8:11], s50 offen offset:2048 sc1
    buffer_load_dwordx4 a[12:15], v116, s[8:11], s50 offen offset:3072 sc1
    s_add_u32 s50, s50, 4096
    buffer_load_dwordx4 a[16:19], v116, s[8:11], s50 offen offset:0 sc1
    buffer_load_dwordx4 a[20:23], v116, s[8:11], s50 offen offset:1024 sc1
    buffer_load_dwordx4 a[24:27], v116, s[8:11], s50 offen offset:2048 sc1
    buffer_load_dwordx4 a[28:31], v116, s[8:11], s50 offen offset:3072 sc1
    s_add_u32 s50, s50, 4096
    s_waitcnt vmcnt(8)
    v_and_b32 v24, 0xffff0000, v16
    v_lshlrev_b32 v16, 16, v16
    v_and_b32 v25, 0xffff0000, v17
    v_lshlrev_b32 v17, 16, v17
    v_and_b32 v26, 0xffff0000, v18
    v_lshlrev_b32 v18, 16, v18
    v_and_b32 v27, 0xffff0000, v19
    v_lshlrev_b32 v19, 16, v19
    v_and_b32 v28, 0xffff0000, v20
    v_lshlrev_b32 v20, 16, v20
    v_and_b32 v29, 0xffff0000, v21
    v_lshlrev_b32 v21, 16, v21
    v_and_b32 v30, 0xffff0000, v22
    v_lshlrev_b32 v22, 16, v22
    v_and_b32 v31, 0xffff0000, v23
    v_lshlrev_b32 v23, 16, v23
    s_branch L_cv_rcp
L_cv_fin:
    s_mov_b32 s54, 0x3b000000
    s_mov_b32 s55, 0x3b000000
    s_mov_b32 s56, 0x3727c5ac
    s_mov_b32 s57, 0x3727c5ac
    s_waitcnt vmcnt(4)
    v_pk_mul_f32 v[16:17], v[16:17], s[54:55]
    v_pk_mul_f32 v[24:25], v[24:25], s[54:55]
    v_pk_fma_f32 v[24:25], v[16:17], v[16:17], v[24:25] neg_lo:[1,0,0] neg_hi:[1,0,0]
    v_cvt_pk_bf16_f32 v16, v16, v17
    v_and_b32 v17, 0xffff0000, v16
    v_lshlrev_b32 v16, 16, v16
    v_max_f32 v24, 0, v24
    v_max_f32 v25, 0, v25
    v_cvt_pk_bf16_f32 v24, v24, v25
    v_and_b32 v25, 0xffff0000, v24
    v_lshlrev_b32 v24, 16, v24
    v_pk_add_f32 v[24:25], v[24:25], s[56:57]
    v_cvt_pk_bf16_f32 v24, v24, v25
    v_and_b32 v25, 0xffff0000, v24
    v_lshlrev_b32 v24, 16, v24
    v_sqrt_f32 v24, v24
    v_sqrt_f32 v25, v25
    s_nop 0
    v_cvt_pk_bf16_f32 v24, v24, v25
    v_and_b32 v25, 0xffff0000, v24
    v_lshlrev_b32 v24, 16, v24
    v_pk_mul_f32 v[18:19], v[18:19], s[54:55]
    v_pk_mul_f32 v[26:27], v[26:27], s[54:55]
    v_pk_fma_f32 v[26:27], v[18:19], v[18:19], v[26:27] neg_lo:[1,0,0] neg_hi:[1,0,0]
    v_cvt_pk_bf16_f32 v18, v18, v19
    v_and_b32 v19, 0xffff0000, v18
    v_lshlrev_b32 v18, 16, v18
    v_max_f32 v26, 0, v26
    v_max_f32 v27, 0, v27
    v_cvt_pk_bf16_f32 v26, v26, v27
    v_and_b32 v27, 0xffff0000, v26
    v_lshlrev_b32 v26, 16, v26
    v_pk_add_f32 v[26:27], v[26:27], s[56:57]
    v_cvt_pk_bf16_f32 v26, v26, v27
    v_and_b32 v27, 0xffff0000, v26
    v_lshlrev_b32 v26, 16, v26
    v_sqrt_f32 v26, v26
    v_sqrt_f32 v27, v27
    s_nop 0
    v_cvt_pk_bf16_f32 v26, v26, v27
    v_and_b32 v27, 0xffff0000, v26
    v_lshlrev_b32 v26, 16, v26
    s_waitcnt vmcnt(2)
    v_pk_mul_f32 v[20:21], v[20:21], s[54:55]
    v_pk_mul_f32 v[28:29], v[28:29], s[54:55]
    v_pk_fma_f32 v[28:29], v[20:21], v[20:21], v[28:29] neg_lo:[1,0,0] neg_hi:[1,0,0]
    v_cvt_pk_bf16_f32 v20, v20, v21
    v_and_b32 v21, 0xffff0000, v20
    v_lshlrev_b32 v20, 16, v20
    v_max_f32 v28, 0, v28
    v_max_f32 v29, 0, v29
    v_cvt_pk_bf16_f32 v28, v28, v29
    v_and_b32 v29, 0xffff0000, v28
    v_lshlrev_b32 v28, 16, v28
    v_pk_add_f32 v[28:29], v[28:29], s[56:57]
    v_cvt_pk_bf16_f32 v28, v28, v29
    v_and_b32 v29, 0xffff0000, v28
    v_lshlrev_b32 v28, 16, v28
    v_sqrt_f32 v28, v28
    v_sqrt_f32 v29, v29
    s_nop 0
    v_cvt_pk_bf16_f32 v28, v28, v29
    v_and_b32 v29, 0xffff0000, v28
    v_lshlrev_b32 v28, 16, v28
    v_pk_mul_f32 v[22:23], v[22:23], s[54:55]
    v_pk_mul_f32 v[30:31], v[30:31], s[54:55]
    v_pk_fma_f32 v[30:31], v[22:23], v[22:23], v[30:31] neg_lo:[1,0,0] neg_hi:[1,0,0]
    v_cvt_pk_bf16_f32 v22, v22, v23
    v_and_b32 v23, 0xffff0000, v22
    v_lshlrev_b32 v22, 16, v22
    v_max_f32 v30, 0, v30
    v_max_f32 v31, 0, v31
    v_cvt_pk_bf16_f32 v30, v30, v31
    v_and_b32 v31, 0xffff0000, v30
    v_lshlrev_b32 v30, 16, v30
    v_pk_add_f32 v[30:31], v[30:31], s[56:57]
    v_cvt_pk_bf16_f32 v30, v30, v31
    v_and_b32 v31, 0xffff0000, v30
    v_lshlrev_b32 v30, 16, v30
    v_sqrt_f32 v30, v30
    v_sqrt_f32 v31, v31
    s_nop 0
    v_cvt_pk_bf16_f32 v30, v30, v31
    v_and_b32 v31, 0xffff0000, v30
    v_lshlrev_b32 v30, 16, v30
    s_waitcnt vmcnt(0)
L_cv_rcp:
    v_rcp_f32 v24, v24
    v_rcp_f32 v25, v25
    v_rcp_f32 v26, v26
    v_rcp_f32 v27, v27
    v_rcp_f32 v28, v28
    v_rcp_f32 v29, v29
    v_rcp_f32 v30, v30
    v_rcp_f32 v31, v31
    ds_write_b128 v2, v[32:35] offset:58880
    v_lshlrev_b32 v4, 16, v32
    v_and_b32 v5, 0xffff0000, v32
    v_pk_add_f32 v[4:5], v[4:5], v[16:17] neg_lo:[0,1] neg_hi:[0,1]
    v_cvt_pk_bf16_f32 v4, v4, v5
    v_and_b32 v5, 0xffff0000, v4
    v_lshlrev_b32 v4, 16, v4
    v_pk_mul_f32 v[4:5], v[4:5], v[24:25]
    v_cvt_pk_bf16_f32 v40, v4, v5
    v_lshlrev_b32 v4, 16, v33
    v_and_b32 v5, 0xffff0000, v33
    v_pk_add_f32 v[4:5], v[4:5], v[18:19] neg_lo:[0,1] neg_hi:[0,1]
    v_cvt_pk_bf16_f32 v4, v4, v5
    v_and_b32 v5, 0xffff0000, v4
    v_lshlrev_b32 v4, 16, v4
    v_pk_mul_f32 v[4:5], v[4:5], v[26:27]
    v_cvt_pk_bf16_f32 v41, v4, v5
    v_lshlrev_b32 v4, 16, v34
    v_and_b32 v5, 0xffff0000, v34
    v_pk_add_f32 v[4:5], v[4:5], v[20:21] neg_lo:[0,1] neg_hi:[0,1]
    v_cvt_pk_bf16_f32 v4, v4, v5
    v_and_b32 v5, 0xffff0000, v4
    v_lshlrev_b32 v4, 16, v4
    v_pk_mul_f32 v[4:5], v[4:5], v[28:29]
    v_cvt_pk_bf16_f32 v42, v4, v5
    v_lshlrev_b32 v4, 16, v35
    v_and_b32 v5, 0xffff0000, v35
    v_pk_add_f32 v[4:5], v[4:5], v[22:23] neg_lo:[0,1] neg_hi:[0,1]
    v_cvt_pk_bf16_f32 v4, v4, v5
    v_and_b32 v5, 0xffff0000, v4
    v_lshlrev_b32 v4, 16, v4
    v_pk_mul_f32 v[4:5], v[4:5], v[30:31]
    v_cvt_pk_bf16_f32 v43, v4, v5
    ds_write_b128 v2, v[40:43] offset:512
    ds_write_b128 v2, v[36:39] offset:62976
    v_lshlrev_b32 v4, 16, v36
    v_and_b32 v5, 0xffff0000, v36
    v_pk_add_f32 v[4:5], v[4:5], v[16:17] neg_lo:[0,1] neg_hi:[0,1]
    v_cvt_pk_bf16_f32 v4, v4, v5
    v_and_b32 v5, 0xffff0000, v4
    v_lshlrev_b32 v4, 16, v4
    v_pk_mul_f32 v[4:5], v[4:5], v[24:25]
    v_cvt_pk_bf16_f32 v44, v4, v5
    v_lshlrev_b32 v4, 16, v37
    v_and_b32 v5, 0xffff0000, v37
    v_pk_add_f32 v[4:5], v[4:5], v[18:19] neg_lo:[0,1] neg_hi:[0,1]
    v_cvt_pk_bf16_f32 v4, v4, v5
    v_and_b32 v5, 0xffff0000, v4
    v_lshlrev_b32 v4, 16, v4
    v_pk_mul_f32 v[4:5], v[4:5], v[26:27]
    v_cvt_pk_bf16_f32 v45, v4, v5
    v_lshlrev_b32 v4, 16, v38
    v_and_b32 v5, 0xffff0000, v38
    v_pk_add_f32 v[4:5], v[4:5], v[20:21] neg_lo:[0,1] neg_hi:[0,1]
    v_cvt_pk_bf16_f32 v4, v4, v5
    v_and_b32 v5, 0xffff0000, v4
    v_lshlrev_b32 v4, 16, v4
    v_pk_mul_f32 v[4:5], v[4:5], v[28:29]
    v_cvt_pk_bf16_f32 v46, v4, v5
    v_lshlrev_b32 v4, 16, v39
    v_and_b32 v5, 0xffff0000, v39
    v_pk_add_f32 v[4:5], v[4:5], v[22:23] neg_lo:[0,1] neg_hi:[0,1]
    v_cvt_pk_bf16_f32 v4, v4, v5
    v_and_b32 v5, 0xffff0000, v4
    v_lshlrev_b32 v4, 16, v4
    v_pk_mul_f32 v[4:5], v[4:5], v[30:31]
    v_cvt_pk_bf16_f32 v47, v4, v5
    ds_write_b128 v2, v[44:47] offset:5120
    s_waitcnt lgkmcnt(0)
    s_barrier
    s_cmp_lg_u32 s29, 0
    s_cbranch_scc1 L_cm1
    ds_read_b64_tr_b16 v[16:17], v12 offset:8
    ds_read_b64_tr_b16 v[18:19], v12 offset:0
    ds_read_b128 v[20:23], v13 offset:192
    ds_read_b128 v[24:27], v13 offset:704
    ds_read_b128 v[28:31], v13 offset:1216
    ds_read_b128 v[32:35], v13 offset:1728
    ds_read_b128 v[36:39], v13 offset:2240
    ds_read_b128 v[40:43], v13 offset:2752
    ds_read_b128 v[44:47], v13 offset:3264
    ds_read_b128 v[48:51], v13 offset:3776
    s_waitcnt lgkmcnt(7)
    v_mfma_f32_16x16x32_bf16 a[224:227], v[16:19], v[20:23], 0
    ds_read_b64_tr_b16 v[52:53], v12 offset:520
    ds_read_b64_tr_b16 v[54:55], v12 offset:512
    s_waitcnt lgkmcnt(8)
    v_mfma_f32_16x16x32_bf16 a[228:231], v[16:19], v[24:27], 0
    ds_read_b64_tr_b16 v[56:57], v12 offset:1032
    ds_read_b64_tr_b16 v[58:59], v12 offset:1024
    s_waitcnt lgkmcnt(9)
    v_mfma_f32_16x16x32_bf16 a[232:235], v[16:19], v[28:31], 0
    ds_read_b64_tr_b16 v[60:61], v12 offset:1544
    ds_read_b64_tr_b16 v[62:63], v12 offset:1536
    s_waitcnt lgkmcnt(10)
    v_mfma_f32_16x16x32_bf16 a[236:239], v[16:19], v[32:35], 0
    ds_read_b64_tr_b16 v[64:65], v12 offset:2056
    ds_read_b64_tr_b16 v[66:67], v12 offset:2048
    s_waitcnt lgkmcnt(11)
    v_mfma_f32_16x16x32_bf16 a[240:243], v[16:19], v[36:39], 0
    ds_read_b64_tr_b16 v[68:69], v12 offset:2568
    ds_read_b64_tr_b16 v[70:71], v12 offset:2560
    buffer_load_dwordx4 a[32:35], v116, s[8:11], s50 offen offset:0 sc1
    s_waitcnt lgkmcnt(12)
    v_mfma_f32_16x16x32_bf16 a[244:247], v[16:19], v[40:43], 0
    ds_read_b64_tr_b16 v[72:73], v12 offset:3080
    ds_read_b64_tr_b16 v[74:75], v12 offset:3072
    s_waitcnt lgkmcnt(13)
    v_mfma_f32_16x16x32_bf16 a[248:251], v[16:19], v[44:47], 0
    ds_read_b64_tr_b16 v[76:77], v12 offset:3592
    ds_read_b64_tr_b16 v[78:79], v12 offset:3584
    s_waitcnt lgkmcnt(14)
    v_mfma_f32_16x16x32_bf16 a[252:255], v[16:19], v[48:51], 0
    ds_read_b64_tr_b16 v[80:81], v12 offset:3656
    ds_read_b64_tr_b16 v[82:83], v12 offset:3648
    s_waitcnt lgkmcnt(14)
    v_mfma_f32_16x16x32_bf16 a[228:231], v[52:55], v[20:23], a[228:231]
    ds_read_b128 v[84:87], v13 offset:128
    v_mfma_f32_16x16x32_bf16 a[232:235], v[52:55], v[24:27], a[232:235]
    ds_read_b64_tr_b16 v[88:89], v12 offset:3144
    ds_read_b64_tr_b16 v[90:91], v12 offset:3136
    v_mfma_f32_16x16x32_bf16 a[236:239], v[52:55], v[28:31], a[236:239]
    ds_read_b128 v[92:95], v13 offset:640
    v_mfma_f32_16x16x32_bf16 a[240:243], v[52:55], v[32:35], a[240:243]
    ds_read_b64_tr_b16 v[96:97], v12 offset:2632
    ds_read_b64_tr_b16 v[98:99], v12 offset:2624
    buffer_load_dwordx4 a[36:39], v116, s[8:11], s50 offen offset:1024 sc1
    v_mfma_f32_16x16x32_bf16 a[244:247], v[52:55], v[36:39], a[244:247]
    ds_read_b128 v[100:103], v13 offset:1152
    v_mfma_f32_16x16x32_bf16 a[248:251], v[52:55], v[40:43], a[248:251]
    ds_read_b64_tr_b16 v[104:105], v12 offset:2120
    ds_read_b64_tr_b16 v[106:107], v12 offset:2112
    v_mfma_f32_16x16x32_bf16 a[252:255], v[52:55], v[44:47], a[252:255]
    ds_read_b128 v[108:111], v13 offset:1664
    s_waitcnt lgkmcnt(15)
    v_mfma_f32_16x16x32_bf16 a[232:235], v[56:59], v[20:23], a[232:235]
    ds_read_b64_tr_b16 v[16:17], v12 offset:1608
    ds_read_b64_tr_b16 v[18:19], v12 offset:1600
    v_mfma_f32_16x16x32_bf16 a[236:239], v[56:59], v[24:27], a[236:239]
    ds_read_b128 v[48:51], v13 offset:2176
    v_mfma_f32_16x16x32_bf16 a[240:243], v[56:59], v[28:31], a[240:243]
    ds_read_b64_tr_b16 v[52:53], v12 offset:1096
    ds_read_b64_tr_b16 v[54:55], v12 offset:1088
    v_mfma_f32_16x16x32_bf16 a[244:247], v[56:59], v[32:35], a[244:247]
    ds_read_b128 v[44:47], v13 offset:2688
    buffer_load_dwordx4 a[40:43], v116, s[8:11], s50 offen offset:2048 sc1
    v_mfma_f32_16x16x32_bf16 a[248:251], v[56:59], v[36:39], a[248:251]
    v_mfma_f32_16x16x32_bf16 a[252:255], v[56:59], v[40:43], a[252:255]
    ds_read_b64_tr_b16 v[56:57], v12 offset:584
    ds_read_b64_tr_b16 v[58:59], v12 offset:576
    v_mfma_f32_16x16x32_bf16 a[236:239], v[60:63], v[20:23], a[236:239]
    ds_read_b128 v[40:43], v13 offset:3200
    v_mfma_f32_16x16x32_bf16 a[240:243], v[60:63], v[24:27], a[240:243]
    v_mfma_f32_16x16x32_bf16 a[244:247], v[60:63], v[28:31], a[244:247]
    v_mfma_f32_16x16x32_bf16 a[248:251], v[60:63], v[32:35], a[248:251]
    v_mfma_f32_16x16x32_bf16 a[252:255], v[60:63], v[36:39], a[252:255]
    ds_read_b64_tr_b16 v[60:61], v12 offset:72
    ds_read_b64_tr_b16 v[62:63], v12 offset:64
    buffer_load_dwordx4 a[44:47], v116, s[8:11], s50 offen offset:3072 sc1
    s_add_u32 s50, s50, 4096
    v_mfma_f32_16x16x32_bf16 a[240:243], v[64:67], v[20:23], a[240:243]
    ds_read_b128 v[36:39], v13 offset:3712
    v_mfma_f32_16x16x32_bf16 a[244:247], v[64:67], v[24:27], a[244:247]
    v_mfma_f32_16x16x32_bf16 a[248:251], v[64:67], v[28:31], a[248:251]
    v_mfma_f32_16x16x32_bf16 a[252:255], v[64:67], v[32:35], a[252:255]
    ds_read_b64_tr_b16 v[64:65], v12 offset:136
    ds_read_b64_tr_b16 v[66:67], v12 offset:128
    v_mfma_f32_16x16x32_bf16 a[244:247], v[68:71], v[20:23], a[244:247]
    ds_read_b128 v[32:35], v13 offset:64
    v_mfma_f32_16x16x32_bf16 a[248:251], v[68:71], v[24:27], a[248:251]
    v_mfma_f32_16x16x32_bf16 a[252:255], v[68:71], v[28:31], a[252:255]
    ds_read_b128 v[68:71], v13 offset:576
    buffer_load_dwordx4 a[48:51], v116, s[8:11], s50 offen offset:0 sc1
    s_waitcnt lgkmcnt(15)
    v_mfma_f32_16x16x32_bf16 a[248:251], v[72:75], v[20:23], a[248:251]
    ds_read_b128 v[28:31], v13 offset:1088
    v_mfma_f32_16x16x32_bf16 a[252:255], v[72:75], v[24:27], a[252:255]
    ds_read_b128 v[72:75], v13 offset:1600
    v_mfma_f32_16x16x32_bf16 a[252:255], v[76:79], v[20:23], a[252:255]
    ds_read_b128 v[24:27], v13 offset:2112
    v_mfma_f32_16x16x32_bf16 a[252:255], v[80:83], v[84:87], a[252:255]
    ds_read_b128 v[76:79], v13 offset:2624
    v_mfma_f32_16x16x32_bf16 a[248:251], v[88:91], v[84:87], a[248:251]
    ds_read_b128 v[20:23], v13 offset:3136
    v_mfma_f32_16x16x32_bf16 a[252:255], v[88:91], v[92:95], a[252:255]
    ds_read_b128 v[80:83], v13 offset:3648
    v_mfma_f32_16x16x32_bf16 a[244:247], v[96:99], v[84:87], a[244:247]
    ds_read_b64_tr_b16 v[88:89], v12 offset:648
    ds_read_b64_tr_b16 v[90:91], v12 offset:640
    buffer_load_dwordx4 a[52:55], v116, s[8:11], s50 offen offset:1024 sc1
    v_mfma_f32_16x16x32_bf16 a[248:251], v[96:99], v[92:95], a[248:251]
    v_mfma_f32_16x16x32_bf16 a[252:255], v[96:99], v[100:103], a[252:255]
    ds_read_b64_tr_b16 v[96:97], v12 offset:1160
    ds_read_b64_tr_b16 v[98:99], v12 offset:1152
    v_mfma_f32_16x16x32_bf16 a[240:243], v[104:107], v[84:87], a[240:243]
    v_mfma_f32_16x16x32_bf16 a[244:247], v[104:107], v[92:95], a[244:247]
    v_mfma_f32_16x16x32_bf16 a[248:251], v[104:107], v[100:103], a[248:251]
    v_mfma_f32_16x16x32_bf16 a[252:255], v[104:107], v[108:111], a[252:255]
    ds_read_b64_tr_b16 v[104:105], v12 offset:1672
    ds_read_b64_tr_b16 v[106:107], v12 offset:1664
    s_waitcnt lgkmcnt(15)
    v_mfma_f32_16x16x32_bf16 a[236:239], v[16:19], v[84:87], a[236:239]
    buffer_load_dwordx4 a[56:59], v116, s[8:11], s50 offen offset:2048 sc1
    v_mfma_f32_16x16x32_bf16 a[240:243], v[16:19], v[92:95], a[240:243]
    v_mfma_f32_16x16x32_bf16 a[244:247], v[16:19], v[100:103], a[244:247]
    v_mfma_f32_16x16x32_bf16 a[248:251], v[16:19], v[108:111], a[248:251]
    v_mfma_f32_16x16x32_bf16 a[252:255], v[16:19], v[48:51], a[252:255]
    ds_read_b64_tr_b16 v[16:17], v12 offset:2184
    ds_read_b64_tr_b16 v[18:19], v12 offset:2176
    v_mfma_f32_16x16x32_bf16 a[232:235], v[52:55], v[84:87], a[232:235]
    v_mfma_f32_16x16x32_bf16 a[236:239], v[52:55], v[92:95], a[236:239]
    v_mfma_f32_16x16x32_bf16 a[240:243], v[52:55], v[100:103], a[240:243]
    buffer_load_dwordx4 a[60:63], v116, s[8:11], s50 offen offset:3072 sc1
    s_add_u32 s50, s50, 4096
    v_mfma_f32_16x16x32_bf16 a[244:247], v[52:55], v[108:111], a[244:247]
    v_mfma_f32_16x16x32_bf16 a[248:251], v[52:55], v[48:51], a[248:251]
    v_mfma_f32_16x16x32_bf16 a[252:255], v[52:55], v[44:47], a[252:255]
    ds_read_b64_tr_b16 v[52:53], v12 offset:2696
    ds_read_b64_tr_b16 v[54:55], v12 offset:2688
    v_mfma_f32_16x16x32_bf16 a[228:231], v[56:59], v[84:87], a[228:231]
    v_mfma_f32_16x16x32_bf16 a[232:235], v[56:59], v[92:95], a[232:235]
    v_mfma_f32_16x16x32_bf16 a[236:239], v[56:59], v[100:103], a[236:239]
    v_mfma_f32_16x16x32_bf16 a[240:243], v[56:59], v[108:111], a[240:243]
    buffer_load_dwordx4 a[64:67], v116, s[8:11], s50 offen offset:0 sc1
    v_mfma_f32_16x16x32_bf16 a[244:247], v[56:59], v[48:51], a[244:247]
    v_mfma_f32_16x16x32_bf16 a[248:251], v[56:59], v[44:47], a[248:251]
    v_mfma_f32_16x16x32_bf16 a[252:255], v[56:59], v[40:43], a[252:255]
    ds_read_b64_tr_b16 v[56:57], v12 offset:3208
    ds_read_b64_tr_b16 v[58:59], v12 offset:3200
    v_mfma_f32_16x16x32_bf16 a[224:227], v[60:63], v[84:87], a[224:227]
    ds_read_b64_tr_b16 v[84:85], v12 offset:3720
    ds_read_b64_tr_b16 v[86:87], v12 offset:3712
    v_mfma_f32_16x16x32_bf16 a[228:231], v[60:63], v[92:95], a[228:231]
    ds_read_b64_tr_b16 v[92:93], v12 offset:3784
    ds_read_b64_tr_b16 v[94:95], v12 offset:3776
    v_mfma_f32_16x16x32_bf16 a[232:235], v[60:63], v[100:103], a[232:235]
    ds_read_b128 v[100:103], v13 offset:0
    v_mfma_f32_16x16x32_bf16 a[236:239], v[60:63], v[108:111], a[236:239]
    ds_read_b64_tr_b16 v[108:109], v12 offset:3272
    ds_read_b64_tr_b16 v[110:111], v12 offset:3264
    buffer_load_dwordx4 a[68:71], v116, s[8:11], s50 offen offset:1024 sc1
    v_mfma_f32_16x16x32_bf16 a[240:243], v[60:63], v[48:51], a[240:243]
    ds_read_b128 v[48:51], v13 offset:512
    v_mfma_f32_16x16x32_bf16 a[244:247], v[60:63], v[44:47], a[244:247]
    ds_read_b64_tr_b16 v[44:45], v12 offset:2760
    ds_read_b64_tr_b16 v[46:47], v12 offset:2752
    v_mfma_f32_16x16x32_bf16 a[248:251], v[60:63], v[40:43], a[248:251]
    ds_read_b128 v[40:43], v13 offset:1024
    v_mfma_f32_16x16x32_bf16 a[252:255], v[60:63], v[36:39], a[252:255]
    ds_read_b64_tr_b16 v[60:61], v12 offset:2248
    ds_read_b64_tr_b16 v[62:63], v12 offset:2240
    s_waitcnt lgkmcnt(15)
    v_mfma_f32_16x16x32_bf16 a[224:227], v[64:67], v[32:35], a[224:227]
    ds_read_b128 v[36:39], v13 offset:1536
    v_mfma_f32_16x16x32_bf16 a[228:231], v[64:67], v[68:71], a[228:231]
    v_mfma_f32_16x16x32_bf16 a[232:235], v[64:67], v[28:31], a[232:235]
    buffer_load_dwordx4 a[72:75], v116, s[8:11], s50 offen offset:2048 sc1
    v_mfma_f32_16x16x32_bf16 a[236:239], v[64:67], v[72:75], a[236:239]
    v_mfma_f32_16x16x32_bf16 a[240:243], v[64:67], v[24:27], a[240:243]
    v_mfma_f32_16x16x32_bf16 a[244:247], v[64:67], v[76:79], a[244:247]
    v_mfma_f32_16x16x32_bf16 a[248:251], v[64:67], v[20:23], a[248:251]
    v_mfma_f32_16x16x32_bf16 a[252:255], v[64:67], v[80:83], a[252:255]
    ds_read_b64_tr_b16 v[64:65], v12 offset:1736
    ds_read_b64_tr_b16 v[66:67], v12 offset:1728
    v_mfma_f32_16x16x32_bf16 a[228:231], v[88:91], v[32:35], a[228:231]
    ds_read_b128 v[80:83], v13 offset:2048
    v_mfma_f32_16x16x32_bf16 a[232:235], v[88:91], v[68:71], a[232:235]
    buffer_load_dwordx4 a[76:79], v116, s[8:11], s50 offen offset:3072 sc1
    s_add_u32 s50, s50, 4096
    v_mfma_f32_16x16x32_bf16 a[236:239], v[88:91], v[28:31], a[236:239]
    v_mfma_f32_16x16x32_bf16 a[240:243], v[88:91], v[72:75], a[240:243]
    v_mfma_f32_16x16x32_bf16 a[244:247], v[88:91], v[24:27], a[244:247]
    v_mfma_f32_16x16x32_bf16 a[248:251], v[88:91], v[76:79], a[248:251]
    v_mfma_f32_16x16x32_bf16 a[252:255], v[88:91], v[20:23], a[252:255]
    ds_read_b64_tr_b16 v[88:89], v12 offset:1224
    ds_read_b64_tr_b16 v[90:91], v12 offset:1216
    v_mfma_f32_16x16x32_bf16 a[232:235], v[96:99], v[32:35], a[232:235]
    ds_read_b128 v[20:23], v13 offset:2560
    v_mfma_f32_16x16x32_bf16 a[236:239], v[96:99], v[68:71], a[236:239]
    buffer_load_dwordx4 a[80:83], v116, s[8:11], s50 offen offset:0 sc1
    v_mfma_f32_16x16x32_bf16 a[240:243], v[96:99], v[28:31], a[240:243]
    v_mfma_f32_16x16x32_bf16 a[244:247], v[96:99], v[72:75], a[244:247]
    v_mfma_f32_16x16x32_bf16 a[248:251], v[96:99], v[24:27], a[248:251]
    v_mfma_f32_16x16x32_bf16 a[252:255], v[96:99], v[76:79], a[252:255]
    ds_read_b64_tr_b16 v[96:97], v12 offset:712
    ds_read_b64_tr_b16 v[98:99], v12 offset:704
    v_mfma_f32_16x16x32_bf16 a[236:239], v[104:107], v[32:35], a[236:239]
    ds_read_b128 v[76:79], v13 offset:3072
    v_mfma_f32_16x16x32_bf16 a[240:243], v[104:107], v[68:71], a[240:243]
    v_mfma_f32_16x16x32_bf16 a[244:247], v[104:107], v[28:31], a[244:247]
    buffer_load_dwordx4 a[84:87], v116, s[8:11], s50 offen offset:1024 sc1
    v_mfma_f32_16x16x32_bf16 a[248:251], v[104:107], v[72:75], a[248:251]
    v_mfma_f32_16x16x32_bf16 a[252:255], v[104:107], v[24:27], a[252:255]
    ds_read_b64_tr_b16 v[104:105], v12 offset:200
    ds_read_b64_tr_b16 v[106:107], v12 offset:192
    v_mfma_f32_16x16x32_bf16 a[240:243], v[16:19], v[32:35], a[240:243]
    ds_read_b128 v[24:27], v13 offset:3584
    v_mfma_f32_16x16x32_bf16 a[244:247], v[16:19], v[68:71], a[244:247]
    v_mfma_f32_16x16x32_bf16 a[248:251], v[16:19], v[28:31], a[248:251]
    v_mfma_f32_16x16x32_bf16 a[252:255], v[16:19], v[72:75], a[252:255]
    v_mfma_f32_16x16x32_bf16 a[244:247], v[52:55], v[32:35], a[244:247]
    buffer_load_dwordx4 a[88:91], v116, s[8:11], s50 offen offset:2048 sc1
    v_mfma_f32_16x16x32_bf16 a[248:251], v[52:55], v[68:71], a[248:251]
    v_mfma_f32_16x16x32_bf16 a[252:255], v[52:55], v[28:31], a[252:255]
    s_waitcnt lgkmcnt(15)
    v_mfma_f32_16x16x32_bf16 a[248:251], v[56:59], v[32:35], a[248:251]
    v_mfma_f32_16x16x32_bf16 a[252:255], v[56:59], v[68:71], a[252:255]
    v_mfma_f32_16x16x32_bf16 a[252:255], v[84:87], v[32:35], a[252:255]
    v_mfma_f32_16x16x32_bf16 a[252:255], v[92:95], v[100:103], a[252:255]
    v_mfma_f32_16x16x32_bf16 a[248:251], v[108:111], v[100:103], a[248:251]
    buffer_load_dwordx4 a[92:95], v116, s[8:11], s50 offen offset:3072 sc1
    s_add_u32 s50, s50, 4096
    v_mfma_f32_16x16x32_bf16 a[252:255], v[108:111], v[48:51], a[252:255]
    v_mfma_f32_16x16x32_bf16 a[244:247], v[44:47], v[100:103], a[244:247]
    v_mfma_f32_16x16x32_bf16 a[248:251], v[44:47], v[48:51], a[248:251]
    v_mfma_f32_16x16x32_bf16 a[252:255], v[44:47], v[40:43], a[252:255]
    s_waitcnt lgkmcnt(13)
    v_mfma_f32_16x16x32_bf16 a[240:243], v[60:63], v[100:103], a[240:243]
    v_mfma_f32_16x16x32_bf16 a[244:247], v[60:63], v[48:51], a[244:247]
    v_mfma_f32_16x16x32_bf16 a[248:251], v[60:63], v[40:43], a[248:251]
    buffer_load_dwordx4 a[96:99], v116, s[8:11], s50 offen offset:0 sc1
    s_waitcnt lgkmcnt(12)
    v_mfma_f32_16x16x32_bf16 a[252:255], v[60:63], v[36:39], a[252:255]
    s_waitcnt lgkmcnt(10)
    v_mfma_f32_16x16x32_bf16 a[236:239], v[64:67], v[100:103], a[236:239]
    v_mfma_f32_16x16x32_bf16 a[240:243], v[64:67], v[48:51], a[240:243]
    v_mfma_f32_16x16x32_bf16 a[244:247], v[64:67], v[40:43], a[244:247]
    v_mfma_f32_16x16x32_bf16 a[248:251], v[64:67], v[36:39], a[248:251]
    s_waitcnt lgkmcnt(9)
    v_mfma_f32_16x16x32_bf16 a[252:255], v[64:67], v[80:83], a[252:255]
    s_waitcnt lgkmcnt(7)
    v_mfma_f32_16x16x32_bf16 a[232:235], v[88:91], v[100:103], a[232:235]
    buffer_load_dwordx4 a[100:103], v116, s[8:11], s50 offen offset:1024 sc1
    v_mfma_f32_16x16x32_bf16 a[236:239], v[88:91], v[48:51], a[236:239]
    v_mfma_f32_16x16x32_bf16 a[240:243], v[88:91], v[40:43], a[240:243]
    v_mfma_f32_16x16x32_bf16 a[244:247], v[88:91], v[36:39], a[244:247]
    v_mfma_f32_16x16x32_bf16 a[248:251], v[88:91], v[80:83], a[248:251]
    s_waitcnt lgkmcnt(6)
    v_mfma_f32_16x16x32_bf16 a[252:255], v[88:91], v[20:23], a[252:255]
    s_waitcnt lgkmcnt(4)
    v_mfma_f32_16x16x32_bf16 a[228:231], v[96:99], v[100:103], a[228:231]
    v_mfma_f32_16x16x32_bf16 a[232:235], v[96:99], v[48:51], a[232:235]
    v_mfma_f32_16x16x32_bf16 a[236:239], v[96:99], v[40:43], a[236:239]
    v_mfma_f32_16x16x32_bf16 a[240:243], v[96:99], v[36:39], a[240:243]
    v_mfma_f32_16x16x32_bf16 a[244:247], v[96:99], v[80:83], a[244:247]
    v_mfma_f32_16x16x32_bf16 a[248:251], v[96:99], v[20:23], a[248:251]
    s_waitcnt lgkmcnt(3)
    v_mfma_f32_16x16x32_bf16 a[252:255], v[96:99], v[76:79], a[252:255]
    s_waitcnt lgkmcnt(1)
    v_mfma_f32_16x16x32_bf16 a[224:227], v[104:107], v[100:103], a[224:227]
    v_mfma_f32_16x16x32_bf16 a[228:231], v[104:107], v[48:51], a[228:231]
    v_mfma_f32_16x16x32_bf16 a[232:235], v[104:107], v[40:43], a[232:235]
    v_mfma_f32_16x16x32_bf16 a[236:239], v[104:107], v[36:39], a[236:239]
    v_mfma_f32_16x16x32_bf16 a[240:243], v[104:107], v[80:83], a[240:243]
    v_mfma_f32_16x16x32_bf16 a[244:247], v[104:107], v[20:23], a[244:247]
    v_mfma_f32_16x16x32_bf16 a[248:251], v[104:107], v[76:79], a[248:251]
    s_waitcnt lgkmcnt(0)
    v_mfma_f32_16x16x32_bf16 a[252:255], v[104:107], v[24:27], a[252:255]
    s_branch L_cm2
L_cm1:
    ds_read_b64_tr_b16 v[16:17], v12 offset:8
    ds_read_b64_tr_b16 v[18:19], v12 offset:0
    ds_read_b128 v[20:23], v13 offset:192
    ds_read_b128 v[24:27], v13 offset:704
    ds_read_b128 v[28:31], v13 offset:1216
    ds_read_b128 v[32:35], v13 offset:1728
    ds_read_b128 v[36:39], v13 offset:2240
    ds_read_b128 v[40:43], v13 offset:2752
    ds_read_b128 v[44:47], v13 offset:3264
    ds_read_b128 v[48:51], v13 offset:3776
    s_waitcnt lgkmcnt(7)
    v_mfma_f32_16x16x32_bf16 a[224:227], v[16:19], v[20:23], 0
    ds_read_b64_tr_b16 v[52:53], v12 offset:520
    ds_read_b64_tr_b16 v[54:55], v12 offset:512
    s_waitcnt lgkmcnt(8)
    v_mfma_f32_16x16x32_bf16 a[228:231], v[16:19], v[24:27], 0
    ds_read_b64_tr_b16 v[56:57], v12 offset:1032
    ds_read_b64_tr_b16 v[58:59], v12 offset:1024
    s_waitcnt lgkmcnt(9)
    v_mfma_f32_16x16x32_bf16 a[232:235], v[16:19], v[28:31], 0
    ds_read_b64_tr_b16 v[60:61], v12 offset:1544
    ds_read_b64_tr_b16 v[62:63], v12 offset:1536
    s_waitcnt lgkmcnt(10)
    v_mfma_f32_16x16x32_bf16 a[236:239], v[16:19], v[32:35], 0
    ds_read_b64_tr_b16 v[64:65], v12 offset:2056
    ds_read_b64_tr_b16 v[66:67], v12 offset:2048
    s_waitcnt lgkmcnt(11)
    v_mfma_f32_16x16x32_bf16 a[240:243], v[16:19], v[36:39], 0
    ds_read_b64_tr_b16 v[68:69], v12 offset:2568
    ds_read_b64_tr_b16 v[70:71], v12 offset:2560
    s_waitcnt lgkmcnt(12)
    v_mfma_f32_16x16x32_bf16 a[244:247], v[16:19], v[40:43], 0
    ds_read_b64_tr_b16 v[72:73], v12 offset:3080
    ds_read_b64_tr_b16 v[74:75], v12 offset:3072
    s_waitcnt lgkmcnt(13)
    v_mfma_f32_16x16x32_bf16 a[248:251], v[16:19], v[44:47], 0
    ds_read_b64_tr_b16 v[76:77], v12 offset:3592
    ds_read_b64_tr_b16 v[78:79], v12 offset:3584
    s_waitcnt lgkmcnt(14)
    v_mfma_f32_16x16x32_bf16 a[252:255], v[16:19], v[48:51], 0
    ds_read_b64_tr_b16 v[80:81], v12 offset:3656
    ds_read_b64_tr_b16 v[82:83], v12 offset:3648
    s_waitcnt lgkmcnt(14)
    v_mfma_f32_16x16x32_bf16 a[228:231], v[52:55], v[20:23], a[228:231]
    ds_read_b128 v[84:87], v13 offset:128
    v_mfma_f32_16x16x32_bf16 a[232:235], v[52:55], v[24:27], a[232:235]
    ds_read_b64_tr_b16 v[88:89], v12 offset:3144
    ds_read_b64_tr_b16 v[90:91], v12 offset:3136
    v_mfma_f32_16x16x32_bf16 a[236:239], v[52:55], v[28:31], a[236:239]
    ds_read_b128 v[92:95], v13 offset:640
    v_mfma_f32_16x16x32_bf16 a[240:243], v[52:55], v[32:35], a[240:243]
    ds_read_b64_tr_b16 v[96:97], v12 offset:2632
    ds_read_b64_tr_b16 v[98:99], v12 offset:2624
    v_mfma_f32_16x16x32_bf16 a[244:247], v[52:55], v[36:39], a[244:247]
    ds_read_b128 v[100:103], v13 offset:1152
    v_mfma_f32_16x16x32_bf16 a[248:251], v[52:55], v[40:43], a[248:251]
    ds_read_b64_tr_b16 v[104:105], v12 offset:2120
    ds_read_b64_tr_b16 v[106:107], v12 offset:2112
    v_mfma_f32_16x16x32_bf16 a[252:255], v[52:55], v[44:47], a[252:255]
    ds_read_b128 v[108:111], v13 offset:1664
    s_waitcnt lgkmcnt(15)
    v_mfma_f32_16x16x32_bf16 a[232:235], v[56:59], v[20:23], a[232:235]
    ds_read_b64_tr_b16 v[16:17], v12 offset:1608
    ds_read_b64_tr_b16 v[18:19], v12 offset:1600
    v_mfma_f32_16x16x32_bf16 a[236:239], v[56:59], v[24:27], a[236:239]
    ds_read_b128 v[48:51], v13 offset:2176
    v_mfma_f32_16x16x32_bf16 a[240:243], v[56:59], v[28:31], a[240:243]
    ds_read_b64_tr_b16 v[52:53], v12 offset:1096
    ds_read_b64_tr_b16 v[54:55], v12 offset:1088
    v_mfma_f32_16x16x32_bf16 a[244:247], v[56:59], v[32:35], a[244:247]
    ds_read_b128 v[44:47], v13 offset:2688
    v_mfma_f32_16x16x32_bf16 a[248:251], v[56:59], v[36:39], a[248:251]
    v_mfma_f32_16x16x32_bf16 a[252:255], v[56:59], v[40:43], a[252:255]
    ds_read_b64_tr_b16 v[56:57], v12 offset:584
    ds_read_b64_tr_b16 v[58:59], v12 offset:576
    v_mfma_f32_16x16x32_bf16 a[236:239], v[60:63], v[20:23], a[236:239]
    ds_read_b128 v[40:43], v13 offset:3200
    v_mfma_f32_16x16x32_bf16 a[240:243], v[60:63], v[24:27], a[240:243]
    v_mfma_f32_16x16x32_bf16 a[244:247], v[60:63], v[28:31], a[244:247]
    v_mfma_f32_16x16x32_bf16 a[248:251], v[60:63], v[32:35], a[248:251]
    v_mfma_f32_16x16x32_bf16 a[252:255], v[60:63], v[36:39], a[252:255]
    ds_read_b64_tr_b16 v[60:61], v12 offset:72
    ds_read_b64_tr_b16 v[62:63], v12 offset:64
    v_mfma_f32_16x16x32_bf16 a[240:243], v[64:67], v[20:23], a[240:243]
    ds_read_b128 v[36:39], v13 offset:3712
    v_mfma_f32_16x16x32_bf16 a[244:247], v[64:67], v[24:27], a[244:247]
    v_mfma_f32_16x16x32_bf16 a[248:251], v[64:67], v[28:31], a[248:251]
    v_mfma_f32_16x16x32_bf16 a[252:255], v[64:67], v[32:35], a[252:255]
    ds_read_b64_tr_b16 v[64:65], v12 offset:136
    ds_read_b64_tr_b16 v[66:67], v12 offset:128
    v_mfma_f32_16x16x32_bf16 a[244:247], v[68:71], v[20:23], a[244:247]
    ds_read_b128 v[32:35], v13 offset:64
    v_mfma_f32_16x16x32_bf16 a[248:251], v[68:71], v[24:27], a[248:251]
    v_mfma_f32_16x16x32_bf16 a[252:255], v[68:71], v[28:31], a[252:255]
    ds_read_b128 v[68:71], v13 offset:576
    s_waitcnt lgkmcnt(15)
    v_mfma_f32_16x16x32_bf16 a[248:251], v[72:75], v[20:23], a[248:251]
    ds_read_b128 v[28:31], v13 offset:1088
    v_mfma_f32_16x16x32_bf16 a[252:255], v[72:75], v[24:27], a[252:255]
    ds_read_b128 v[72:75], v13 offset:1600
    v_mfma_f32_16x16x32_bf16 a[252:255], v[76:79], v[20:23], a[252:255]
    ds_read_b128 v[24:27], v13 offset:2112
    v_mfma_f32_16x16x32_bf16 a[252:255], v[80:83], v[84:87], a[252:255]
    ds_read_b128 v[76:79], v13 offset:2624
    v_mfma_f32_16x16x32_bf16 a[248:251], v[88:91], v[84:87], a[248:251]
    ds_read_b128 v[20:23], v13 offset:3136
    v_mfma_f32_16x16x32_bf16 a[252:255], v[88:91], v[92:95], a[252:255]
    ds_read_b128 v[80:83], v13 offset:3648
    v_mfma_f32_16x16x32_bf16 a[244:247], v[96:99], v[84:87], a[244:247]
    ds_read_b64_tr_b16 v[88:89], v12 offset:648
    ds_read_b64_tr_b16 v[90:91], v12 offset:640
    v_mfma_f32_16x16x32_bf16 a[248:251], v[96:99], v[92:95], a[248:251]
    v_mfma_f32_16x16x32_bf16 a[252:255], v[96:99], v[100:103], a[252:255]
    ds_read_b64_tr_b16 v[96:97], v12 offset:1160
    ds_read_b64_tr_b16 v[98:99], v12 offset:1152
    v_mfma_f32_16x16x32_bf16 a[240:243], v[104:107], v[84:87], a[240:243]
    v_mfma_f32_16x16x32_bf16 a[244:247], v[104:107], v[92:95], a[244:247]
    v_mfma_f32_16x16x32_bf16 a[248:251], v[104:107], v[100:103], a[248:251]
    v_mfma_f32_16x16x32_bf16 a[252:255], v[104:107], v[108:111], a[252:255]
    ds_read_b64_tr_b16 v[104:105], v12 offset:1672
    ds_read_b64_tr_b16 v[106:107], v12 offset:1664
    s_waitcnt lgkmcnt(15)
    v_mfma_f32_16x16x32_bf16 a[236:239], v[16:19], v[84:87], a[236:239]
    v_mfma_f32_16x16x32_bf16 a[240:243], v[16:19], v[92:95], a[240:243]
    v_mfma_f32_16x16x32_bf16 a[244:247], v[16:19], v[100:103], a[244:247]
    v_mfma_f32_16x16x32_bf16 a[248:251], v[16:19], v[108:111], a[248:251]
    v_mfma_f32_16x16x32_bf16 a[252:255], v[16:19], v[48:51], a[252:255]
    ds_read_b64_tr_b16 v[16:17], v12 offset:2184
    ds_read_b64_tr_b16 v[18:19], v12 offset:2176
    v_mfma_f32_16x16x32_bf16 a[232:235], v[52:55], v[84:87], a[232:235]
    v_mfma_f32_16x16x32_bf16 a[236:239], v[52:55], v[92:95], a[236:239]
    v_mfma_f32_16x16x32_bf16 a[240:243], v[52:55], v[100:103], a[240:243]
    v_mfma_f32_16x16x32_bf16 a[244:247], v[52:55], v[108:111], a[244:247]
    v_mfma_f32_16x16x32_bf16 a[248:251], v[52:55], v[48:51], a[248:251]
    v_mfma_f32_16x16x32_bf16 a[252:255], v[52:55], v[44:47], a[252:255]
    ds_read_b64_tr_b16 v[52:53], v12 offset:2696
    ds_read_b64_tr_b16 v[54:55], v12 offset:2688
    v_mfma_f32_16x16x32_bf16 a[228:231], v[56:59], v[84:87], a[228:231]
    v_mfma_f32_16x16x32_bf16 a[232:235], v[56:59], v[92:95], a[232:235]
    v_mfma_f32_16x16x32_bf16 a[236:239], v[56:59], v[100:103], a[236:239]
    v_mfma_f32_16x16x32_bf16 a[240:243], v[56:59], v[108:111], a[240:243]
    v_mfma_f32_16x16x32_bf16 a[244:247], v[56:59], v[48:51], a[244:247]
    v_mfma_f32_16x16x32_bf16 a[248:251], v[56:59], v[44:47], a[248:251]
    v_mfma_f32_16x16x32_bf16 a[252:255], v[56:59], v[40:43], a[252:255]
    ds_read_b64_tr_b16 v[56:57], v12 offset:3208
    ds_read_b64_tr_b16 v[58:59], v12 offset:3200
    v_mfma_f32_16x16x32_bf16 a[224:227], v[60:63], v[84:87], a[224:227]
    ds_read_b64_tr_b16 v[84:85], v12 offset:3720
    ds_read_b64_tr_b16 v[86:87], v12 offset:3712
    v_mfma_f32_16x16x32_bf16 a[228:231], v[60:63], v[92:95], a[228:231]
    ds_read_b64_tr_b16 v[92:93], v12 offset:3784
    ds_read_b64_tr_b16 v[94:95], v12 offset:3776
    v_mfma_f32_16x16x32_bf16 a[232:235], v[60:63], v[100:103], a[232:235]
    ds_read_b128 v[100:103], v13 offset:0
    v_mfma_f32_16x16x32_bf16 a[236:239], v[60:63], v[108:111], a[236:239]
    ds_read_b64_tr_b16 v[108:109], v12 offset:3272
    ds_read_b64_tr_b16 v[110:111], v12 offset:3264
    v_mfma_f32_16x16x32_bf16 a[240:243], v[60:63], v[48:51], a[240:243]
    ds_read_b128 v[48:51], v13 offset:512
    v_mfma_f32_16x16x32_bf16 a[244:247], v[60:63], v[44:47], a[244:247]
    ds_read_b64_tr_b16 v[44:45], v12 offset:2760
    ds_read_b64_tr_b16 v[46:47], v12 offset:2752
    v_mfma_f32_16x16x32_bf16 a[248:251], v[60:63], v[40:43], a[248:251]
    ds_read_b128 v[40:43], v13 offset:1024
    v_mfma_f32_16x16x32_bf16 a[252:255], v[60:63], v[36:39], a[252:255]
    ds_read_b64_tr_b16 v[60:61], v12 offset:2248
    ds_read_b64_tr_b16 v[62:63], v12 offset:2240
    s_waitcnt lgkmcnt(15)
    v_mfma_f32_16x16x32_bf16 a[224:227], v[64:67], v[32:35], a[224:227]
    ds_read_b128 v[36:39], v13 offset:1536
    v_mfma_f32_16x16x32_bf16 a[228:231], v[64:67], v[68:71], a[228:231]
    v_mfma_f32_16x16x32_bf16 a[232:235], v[64:67], v[28:31], a[232:235]
    v_mfma_f32_16x16x32_bf16 a[236:239], v[64:67], v[72:75], a[236:239]
    v_mfma_f32_16x16x32_bf16 a[240:243], v[64:67], v[24:27], a[240:243]
    v_mfma_f32_16x16x32_bf16 a[244:247], v[64:67], v[76:79], a[244:247]
    v_mfma_f32_16x16x32_bf16 a[248:251], v[64:67], v[20:23], a[248:251]
    v_mfma_f32_16x16x32_bf16 a[252:255], v[64:67], v[80:83], a[252:255]
    ds_read_b64_tr_b16 v[64:65], v12 offset:1736
    ds_read_b64_tr_b16 v[66:67], v12 offset:1728
    v_mfma_f32_16x16x32_bf16 a[228:231], v[88:91], v[32:35], a[228:231]
    ds_read_b128 v[80:83], v13 offset:2048
    v_mfma_f32_16x16x32_bf16 a[232:235], v[88:91], v[68:71], a[232:235]
    v_mfma_f32_16x16x32_bf16 a[236:239], v[88:91], v[28:31], a[236:239]
    v_mfma_f32_16x16x32_bf16 a[240:243], v[88:91], v[72:75], a[240:243]
    v_mfma_f32_16x16x32_bf16 a[244:247], v[88:91], v[24:27], a[244:247]
    v_mfma_f32_16x16x32_bf16 a[248:251], v[88:91], v[76:79], a[248:251]
    v_mfma_f32_16x16x32_bf16 a[252:255], v[88:91], v[20:23], a[252:255]
    ds_read_b64_tr_b16 v[88:89], v12 offset:1224
    ds_read_b64_tr_b16 v[90:91], v12 offset:1216
    v_mfma_f32_16x16x32_bf16 a[232:235], v[96:99], v[32:35], a[232:235]
    ds_read_b128 v[20:23], v13 offset:2560
    v_mfma_f32_16x16x32_bf16 a[236:239], v[96:99], v[68:71], a[236:239]
    v_mfma_f32_16x16x32_bf16 a[240:243], v[96:99], v[28:31], a[240:243]
    v_mfma_f32_16x16x32_bf16 a[244:247], v[96:99], v[72:75], a[244:247]
    v_mfma_f32_16x16x32_bf16 a[248:251], v[96:99], v[24:27], a[248:251]
    v_mfma_f32_16x16x32_bf16 a[252:255], v[96:99], v[76:79], a[252:255]
    ds_read_b64_tr_b16 v[96:97], v12 offset:712
    ds_read_b64_tr_b16 v[98:99], v12 offset:704
    v_mfma_f32_16x16x32_bf16 a[236:239], v[104:107], v[32:35], a[236:239]
    ds_read_b128 v[76:79], v13 offset:3072
    v_mfma_f32_16x16x32_bf16 a[240:243], v[104:107], v[68:71], a[240:243]
    v_mfma_f32_16x16x32_bf16 a[244:247], v[104:107], v[28:31], a[244:247]
    v_mfma_f32_16x16x32_bf16 a[248:251], v[104:107], v[72:75], a[248:251]
    v_mfma_f32_16x16x32_bf16 a[252:255], v[104:107], v[24:27], a[252:255]
    ds_read_b64_tr_b16 v[104:105], v12 offset:200
    ds_read_b64_tr_b16 v[106:107], v12 offset:192
    v_mfma_f32_16x16x32_bf16 a[240:243], v[16:19], v[32:35], a[240:243]
    ds_read_b128 v[24:27], v13 offset:3584
    v_mfma_f32_16x16x32_bf16 a[244:247], v[16:19], v[68:71], a[244:247]
    v_mfma_f32_16x16x32_bf16 a[248:251], v[16:19], v[28:31], a[248:251]
    v_mfma_f32_16x16x32_bf16 a[252:255], v[16:19], v[72:75], a[252:255]
    v_mfma_f32_16x16x32_bf16 a[244:247], v[52:55], v[32:35], a[244:247]
    v_mfma_f32_16x16x32_bf16 a[248:251], v[52:55], v[68:71], a[248:251]
    v_mfma_f32_16x16x32_bf16 a[252:255], v[52:55], v[28:31], a[252:255]
    s_waitcnt lgkmcnt(15)
    v_mfma_f32_16x16x32_bf16 a[248:251], v[56:59], v[32:35], a[248:251]
    v_mfma_f32_16x16x32_bf16 a[252:255], v[56:59], v[68:71], a[252:255]
    v_mfma_f32_16x16x32_bf16 a[252:255], v[84:87], v[32:35], a[252:255]
    v_mfma_f32_16x16x32_bf16 a[252:255], v[92:95], v[100:103], a[252:255]
    v_mfma_f32_16x16x32_bf16 a[248:251], v[108:111], v[100:103], a[248:251]
    v_mfma_f32_16x16x32_bf16 a[252:255], v[108:111], v[48:51], a[252:255]
    v_mfma_f32_16x16x32_bf16 a[244:247], v[44:47], v[100:103], a[244:247]
    v_mfma_f32_16x16x32_bf16 a[248:251], v[44:47], v[48:51], a[248:251]
    v_mfma_f32_16x16x32_bf16 a[252:255], v[44:47], v[40:43], a[252:255]
    s_waitcnt lgkmcnt(13)
    v_mfma_f32_16x16x32_bf16 a[240:243], v[60:63], v[100:103], a[240:243]
    v_mfma_f32_16x16x32_bf16 a[244:247], v[60:63], v[48:51], a[244:247]
    v_mfma_f32_16x16x32_bf16 a[248:251], v[60:63], v[40:43], a[248:251]
    s_waitcnt lgkmcnt(12)
    v_mfma_f32_16x16x32_bf16 a[252:255], v[60:63], v[36:39], a[252:255]
    s_waitcnt lgkmcnt(10)
    v_mfma_f32_16x16x32_bf16 a[236:239], v[64:67], v[100:103], a[236:239]
    v_mfma_f32_16x16x32_bf16 a[240:243], v[64:67], v[48:51], a[240:243]
    v_mfma_f32_16x16x32_bf16 a[244:247], v[64:67], v[40:43], a[244:247]
    v_mfma_f32_16x16x32_bf16 a[248:251], v[64:67], v[36:39], a[248:251]
    s_waitcnt lgkmcnt(9)
    v_mfma_f32_16x16x32_bf16 a[252:255], v[64:67], v[80:83], a[252:255]
    s_waitcnt lgkmcnt(7)
    v_mfma_f32_16x16x32_bf16 a[232:235], v[88:91], v[100:103], a[232:235]
    v_mfma_f32_16x16x32_bf16 a[236:239], v[88:91], v[48:51], a[236:239]
    v_mfma_f32_16x16x32_bf16 a[240:243], v[88:91], v[40:43], a[240:243]
    v_mfma_f32_16x16x32_bf16 a[244:247], v[88:91], v[36:39], a[244:247]
    v_mfma_f32_16x16x32_bf16 a[248:251], v[88:91], v[80:83], a[248:251]
    s_waitcnt lgkmcnt(6)
    v_mfma_f32_16x16x32_bf16 a[252:255], v[88:91], v[20:23], a[252:255]
    s_waitcnt lgkmcnt(4)
    v_mfma_f32_16x16x32_bf16 a[228:231], v[96:99], v[100:103], a[228:231]
    v_mfma_f32_16x16x32_bf16 a[232:235], v[96:99], v[48:51], a[232:235]
    v_mfma_f32_16x16x32_bf16 a[236:239], v[96:99], v[40:43], a[236:239]
    v_mfma_f32_16x16x32_bf16 a[240:243], v[96:99], v[36:39], a[240:243]
    v_mfma_f32_16x16x32_bf16 a[244:247], v[96:99], v[80:83], a[244:247]
    v_mfma_f32_16x16x32_bf16 a[248:251], v[96:99], v[20:23], a[248:251]
    s_waitcnt lgkmcnt(3)
    v_mfma_f32_16x16x32_bf16 a[252:255], v[96:99], v[76:79], a[252:255]
    s_waitcnt lgkmcnt(1)
    v_mfma_f32_16x16x32_bf16 a[224:227], v[104:107], v[100:103], a[224:227]
    v_mfma_f32_16x16x32_bf16 a[228:231], v[104:107], v[48:51], a[228:231]
    v_mfma_f32_16x16x32_bf16 a[232:235], v[104:107], v[40:43], a[232:235]
    v_mfma_f32_16x16x32_bf16 a[236:239], v[104:107], v[36:39], a[236:239]
    v_mfma_f32_16x16x32_bf16 a[240:243], v[104:107], v[80:83], a[240:243]
    v_mfma_f32_16x16x32_bf16 a[244:247], v[104:107], v[20:23], a[244:247]
    v_mfma_f32_16x16x32_bf16 a[248:251], v[104:107], v[76:79], a[248:251]
    s_waitcnt lgkmcnt(0)
    v_mfma_f32_16x16x32_bf16 a[252:255], v[104:107], v[24:27], a[252:255]
L_cm2:
    ds_read_b64 v[64:65], v9 offset:0
    ds_read_b64 v[72:73], v11 offset:0
    ds_read_b64 v[66:67], v9 offset:512
    ds_read_b64 v[74:75], v11 offset:512
    ds_read_b64 v[68:69], v9 offset:1024
    ds_read_b64 v[76:77], v11 offset:1024
    ds_read_b64 v[70:71], v9 offset:1536
    ds_read_b64 v[78:79], v11 offset:1536
    s_cmp_lg_u32 s44, 0
    s_cbranch_scc1 L_cv_r1
    ds_write_b128 v14, a[240:243] offset:0
    ds_write_b128 v14, a[244:247] offset:1024
    ds_write_b128 v14, a[248:251] offset:2048
    ds_write_b128 v14, a[252:255] offset:3072
    v_accvgpr_read_b32 v16, a224
    v_accvgpr_read_b32 v17, a225
    v_accvgpr_read_b32 v18, a226
    v_accvgpr_read_b32 v19, a227
    v_accvgpr_read_b32 v20, a228
    v_accvgpr_read_b32 v21, a229
    v_accvgpr_read_b32 v22, a230
    v_accvgpr_read_b32 v23, a231
    v_accvgpr_read_b32 v24, a232
    v_accvgpr_read_b32 v25, a233
    v_accvgpr_read_b32 v26, a234
    v_accvgpr_read_b32 v27, a235
    v_accvgpr_read_b32 v28, a236
    v_accvgpr_read_b32 v29, a237
    v_accvgpr_read_b32 v30, a238
    v_accvgpr_read_b32 v31, a239
    s_branch L_cv_r2
L_cv_r1:
    ds_write_b128 v14, a[224:227] offset:0
    ds_write_b128 v14, a[228:231] offset:1024
    ds_write_b128 v14, a[232:235] offset:2048
    ds_write_b128 v14, a[236:239] offset:3072
    v_accvgpr_read_b32 v16, a240
    v_accvgpr_read_b32 v17, a241
    v_accvgpr_read_b32 v18, a242
    v_accvgpr_read_b32 v19, a243
    v_accvgpr_read_b32 v20, a244
    v_accvgpr_read_b32 v21, a245
    v_accvgpr_read_b32 v22, a246
    v_accvgpr_read_b32 v23, a247
    v_accvgpr_read_b32 v24, a248
    v_accvgpr_read_b32 v25, a249
    v_accvgpr_read_b32 v26, a250
    v_accvgpr_read_b32 v27, a251
    v_accvgpr_read_b32 v28, a252
    v_accvgpr_read_b32 v29, a253
    v_accvgpr_read_b32 v30, a254
    v_accvgpr_read_b32 v31, a255
L_cv_r2:
    s_cmp_lg_u32 s29, 0
    s_cbranch_scc1 L_cv_w1
    buffer_load_dwordx4 a[104:107], v116, s[8:11], s50 offen offset:2048 sc1
    buffer_load_dwordx4 a[108:111], v116, s[8:11], s50 offen offset:3072 sc1
    s_add_u32 s50, s50, 4096
    s_mov_b32 s50, s35
    buffer_load_dwordx4 a[112:115], v116, s[8:11], s50 offen offset:0 sc1
    buffer_load_dwordx4 a[116:119], v116, s[8:11], s50 offen offset:1024 sc1
    buffer_load_dwordx4 a[120:123], v116, s[8:11], s50 offen offset:2048 sc1
    buffer_load_dwordx4 a[124:127], v116, s[8:11], s50 offen offset:3072 sc1
    s_add_u32 s50, s50, 4096
L_cv_w1:
    s_waitcnt lgkmcnt(4)
    v_lshlrev_b32 v48, 16, v64
    v_and_b32 v49, 0xffff0000, v64
    v_pk_mul_f32 v[48:49], v[48:49], s[48:49] op_sel:[0,1] op_sel_hi:[1,1]
    v_cvt_pk_bf16_f32 v48, v48, v49
    v_and_b32 v49, 0xffff0000, v48
    v_lshlrev_b32 v48, 16, v48
    v_lshlrev_b32 v50, 16, v65
    v_and_b32 v51, 0xffff0000, v65
    v_pk_mul_f32 v[50:51], v[50:51], s[48:49] op_sel:[0,1] op_sel_hi:[1,1]
    v_cvt_pk_bf16_f32 v50, v50, v51
    v_and_b32 v51, 0xffff0000, v50
    v_lshlrev_b32 v50, 16, v50
    v_lshlrev_b32 v52, 16, v66
    v_and_b32 v53, 0xffff0000, v66
    v_pk_mul_f32 v[52:53], v[52:53], s[48:49] op_sel:[0,1] op_sel_hi:[1,1]
    v_cvt_pk_bf16_f32 v52, v52, v53
    v_and_b32 v53, 0xffff0000, v52
    v_lshlrev_b32 v52, 16, v52
    v_lshlrev_b32 v54, 16, v67
    v_and_b32 v55, 0xffff0000, v67
    v_pk_mul_f32 v[54:55], v[54:55], s[48:49] op_sel:[0,1] op_sel_hi:[1,1]
    v_cvt_pk_bf16_f32 v54, v54, v55
    v_and_b32 v55, 0xffff0000, v54
    v_lshlrev_b32 v54, 16, v54
    v_lshlrev_b32 v56, 16, v68
    v_and_b32 v57, 0xffff0000, v68
    v_pk_mul_f32 v[56:57], v[56:57], s[48:49] op_sel:[0,1] op_sel_hi:[1,1]
    v_cvt_pk_bf16_f32 v56, v56, v57
    v_and_b32 v57, 0xffff0000, v56
    v_lshlrev_b32 v56, 16, v56
    v_lshlrev_b32 v58, 16, v69
    v_and_b32 v59, 0xffff0000, v69
    v_pk_mul_f32 v[58:59], v[58:59], s[48:49] op_sel:[0,1] op_sel_hi:[1,1]
    v_cvt_pk_bf16_f32 v58, v58, v59
    v_and_b32 v59, 0xffff0000, v58
    v_lshlrev_b32 v58, 16, v58
    v_lshlrev_b32 v60, 16, v70
    v_and_b32 v61, 0xffff0000, v70
    v_pk_mul_f32 v[60:61], v[60:61], s[48:49] op_sel:[0,1] op_sel_hi:[1,1]
    v_cvt_pk_bf16_f32 v60, v60, v61
    v_and_b32 v61, 0xffff0000, v60
    v_lshlrev_b32 v60, 16, v60
    v_lshlrev_b32 v62, 16, v71
    v_and_b32 v63, 0xffff0000, v71
    v_pk_mul_f32 v[62:63], v[62:63], s[48:49] op_sel:[0,1] op_sel_hi:[1,1]
    v_cvt_pk_bf16_f32 v62, v62, v63
    v_and_b32 v63, 0xffff0000, v62
    v_lshlrev_b32 v62, 16, v62
    s_waitcnt lgkmcnt(0)
    s_barrier
    ds_read_b128 v[32:35], v15 offset:0
    ds_read_b128 v[36:39], v15 offset:1024
    ds_read_b128 v[40:43], v15 offset:2048
    ds_read_b128 v[44:47], v15 offset:3072
    s_waitcnt lgkmcnt(3)
    v_pk_add_f32 v[16:17], v[16:17], v[32:33]
    v_cvt_pk_bf16_f32 v16, v16, v17
    v_and_b32 v17, 0xffff0000, v16
    v_lshlrev_b32 v16, 16, v16
    v_pk_add_f32 v[16:17], v[16:17], v[48:49]
    v_cvt_pk_bf16_f32 v16, v16, v17
    v_and_b32 v17, 0xffff0000, v16
    v_lshlrev_b32 v16, 16, v16
    v_lshlrev_b32 v80, 16, v72
    v_and_b32 v81, 0xffff0000, v72
    v_pk_add_f32 v[16:17], v[16:17], v[80:81]
    v_cvt_pk_bf16_f32 v72, v16, v17
    v_pk_add_f32 v[18:19], v[18:19], v[34:35]
    v_cvt_pk_bf16_f32 v18, v18, v19
    v_and_b32 v19, 0xffff0000, v18
    v_lshlrev_b32 v18, 16, v18
    v_pk_add_f32 v[18:19], v[18:19], v[50:51]
    v_cvt_pk_bf16_f32 v18, v18, v19
    v_and_b32 v19, 0xffff0000, v18
    v_lshlrev_b32 v18, 16, v18
    v_lshlrev_b32 v80, 16, v73
    v_and_b32 v81, 0xffff0000, v73
    v_pk_add_f32 v[18:19], v[18:19], v[80:81]
    v_cvt_pk_bf16_f32 v73, v18, v19
    s_waitcnt lgkmcnt(2)
    v_pk_add_f32 v[20:21], v[20:21], v[36:37]
    v_cvt_pk_bf16_f32 v20, v20, v21
    v_and_b32 v21, 0xffff0000, v20
    v_lshlrev_b32 v20, 16, v20
    v_pk_add_f32 v[20:21], v[20:21], v[52:53]
    v_cvt_pk_bf16_f32 v20, v20, v21
    v_and_b32 v21, 0xffff0000, v20
    v_lshlrev_b32 v20, 16, v20
    v_lshlrev_b32 v80, 16, v74
    v_and_b32 v81, 0xffff0000, v74
    v_pk_add_f32 v[20:21], v[20:21], v[80:81]
    v_cvt_pk_bf16_f32 v74, v20, v21
    v_pk_add_f32 v[22:23], v[22:23], v[38:39]
    v_cvt_pk_bf16_f32 v22, v22, v23
    v_and_b32 v23, 0xffff0000, v22
    v_lshlrev_b32 v22, 16, v22
    v_pk_add_f32 v[22:23], v[22:23], v[54:55]
    v_cvt_pk_bf16_f32 v22, v22, v23
    v_and_b32 v23, 0xffff0000, v22
    v_lshlrev_b32 v22, 16, v22
    v_lshlrev_b32 v80, 16, v75
    v_and_b32 v81, 0xffff0000, v75
    v_pk_add_f32 v[22:23], v[22:23], v[80:81]
    v_cvt_pk_bf16_f32 v75, v22, v23
    s_nop 1
    v_permlane16_swap_b32 v72, v74
    v_permlane16_swap_b32 v73, v75
    buffer_store_dwordx4 v[72:75], v10, s[8:11], s48 offen offset:0 sc1
    s_waitcnt lgkmcnt(1)
    v_pk_add_f32 v[24:25], v[24:25], v[40:41]
    v_cvt_pk_bf16_f32 v24, v24, v25
    v_and_b32 v25, 0xffff0000, v24
    v_lshlrev_b32 v24, 16, v24
    v_pk_add_f32 v[24:25], v[24:25], v[56:57]
    v_cvt_pk_bf16_f32 v24, v24, v25
    v_and_b32 v25, 0xffff0000, v24
    v_lshlrev_b32 v24, 16, v24
    v_lshlrev_b32 v80, 16, v76
    v_and_b32 v81, 0xffff0000, v76
    v_pk_add_f32 v[24:25], v[24:25], v[80:81]
    v_cvt_pk_bf16_f32 v76, v24, v25
    v_pk_add_f32 v[26:27], v[26:27], v[42:43]
    v_cvt_pk_bf16_f32 v26, v26, v27
    v_and_b32 v27, 0xffff0000, v26
    v_lshlrev_b32 v26, 16, v26
    v_pk_add_f32 v[26:27], v[26:27], v[58:59]
    v_cvt_pk_bf16_f32 v26, v26, v27
    v_and_b32 v27, 0xffff0000, v26
    v_lshlrev_b32 v26, 16, v26
    v_lshlrev_b32 v80, 16, v77
    v_and_b32 v81, 0xffff0000, v77
    v_pk_add_f32 v[26:27], v[26:27], v[80:81]
    v_cvt_pk_bf16_f32 v77, v26, v27
    s_waitcnt lgkmcnt(0)
    v_pk_add_f32 v[28:29], v[28:29], v[44:45]
    v_cvt_pk_bf16_f32 v28, v28, v29
    v_and_b32 v29, 0xffff0000, v28
    v_lshlrev_b32 v28, 16, v28
    v_pk_add_f32 v[28:29], v[28:29], v[60:61]
    v_cvt_pk_bf16_f32 v28, v28, v29
    v_and_b32 v29, 0xffff0000, v28
    v_lshlrev_b32 v28, 16, v28
    v_lshlrev_b32 v80, 16, v78
    v_and_b32 v81, 0xffff0000, v78
    v_pk_add_f32 v[28:29], v[28:29], v[80:81]
    v_cvt_pk_bf16_f32 v78, v28, v29
    v_pk_add_f32 v[30:31], v[30:31], v[46:47]
    v_cvt_pk_bf16_f32 v30, v30, v31
    v_and_b32 v31, 0xffff0000, v30
    v_lshlrev_b32 v30, 16, v30
    v_pk_add_f32 v[30:31], v[30:31], v[62:63]
    v_cvt_pk_bf16_f32 v30, v30, v31
    v_and_b32 v31, 0xffff0000, v30
    v_lshlrev_b32 v30, 16, v30
    v_lshlrev_b32 v80, 16, v79
    v_and_b32 v81, 0xffff0000, v79
    v_pk_add_f32 v[30:31], v[30:31], v[80:81]
    v_cvt_pk_bf16_f32 v79, v30, v31
    s_nop 1
    v_permlane16_swap_b32 v76, v78
    v_permlane16_swap_b32 v77, v79
    buffer_store_dwordx4 v[76:79], v10, s[8:11], s48 offen offset:1024 sc1
    s_waitcnt vmcnt(0)
    s_barrier
    s_add_u32 s39, s39, 1
    s_mul_i32 s52, s2, 64
    s_add_u32 s52, s52, 0x180a000
    v_mov_b32 v118, s39
    v_mov_b32 v119, 0
    s_cmp_eq_u32 s3, 0
    s_cselect_b64 exec, 1, 0
    buffer_store_dword v118, v119, s[8:11], s52 offen sc1
    s_mov_b64 exec, -1
    s_cmp_lg_u32 s29, 0
    s_cbranch_scc1 L_cv_nx
    buffer_load_dwordx4 a[128:131], v116, s[8:11], s50 offen offset:0 sc1
    buffer_load_dwordx4 a[132:135], v116, s[8:11], s50 offen offset:1024 sc1
    buffer_load_dwordx4 a[136:139], v116, s[8:11], s50 offen offset:2048 sc1
    buffer_load_dwordx4 a[140:143], v116, s[8:11], s50 offen offset:3072 sc1
    s_add_u32 s50, s50, 4096
    buffer_load_dwordx4 a[144:147], v116, s[8:11], s50 offen offset:0 sc1
    buffer_load_dwordx4 a[148:151], v116, s[8:11], s50 offen offset:1024 sc1
    buffer_load_dwordx4 a[152:155], v116, s[8:11], s50 offen offset:2048 sc1
    buffer_load_dwordx4 a[156:159], v116, s[8:11], s50 offen offset:3072 sc1
    s_add_u32 s50, s50, 4096
    buffer_load_dwordx4 a[160:163], v116, s[8:11], s50 offen offset:0 sc1
    buffer_load_dwordx4 a[164:167], v116, s[8:11], s50 offen offset:1024 sc1
    buffer_load_dwordx4 a[168:171], v116, s[8:11], s50 offen offset:2048 sc1
    buffer_load_dwordx4 a[172:175], v116, s[8:11], s50 offen offset:3072 sc1
    s_add_u32 s50, s50, 4096
    buffer_load_dwordx4 a[176:179], v116, s[8:11], s50 offen offset:0 sc1
    buffer_load_dwordx4 a[180:183], v116, s[8:11], s50 offen offset:1024 sc1
    buffer_load_dwordx4 a[184:187], v116, s[8:11], s50 offen offset:2048 sc1
    buffer_load_dwordx4 a[188:191], v116, s[8:11], s50 offen offset:3072 sc1
    s_add_u32 s50, s50, 4096
    buffer_load_dwordx4 a[192:195], v116, s[8:11], s50 offen offset:0 sc1
    buffer_load_dwordx4 a[196:199], v116, s[8:11], s50 offen offset:1024 sc1
    buffer_load_dwordx4 a[200:203], v116, s[8:11], s50 offen offset:2048 sc1
    buffer_load_dwordx4 a[204:207], v116, s[8:11], s50 offen offset:3072 sc1
    s_add_u32 s50, s50, 4096
    buffer_load_dwordx4 a[208:211], v116, s[8:11], s50 offen offset:0 sc1
    buffer_load_dwordx4 a[212:215], v116, s[8:11], s50 offen offset:1024 sc1
    buffer_load_dwordx4 a[216:219], v116, s[8:11], s50 offen offset:2048 sc1
    buffer_load_dwordx4 a[220:223], v116, s[8:11], s50 offen offset:3072 sc1
    s_add_u32 s50, s50, 4096
    s_mov_b32 s40, 0x3f803f80
    v_mov_b32 v100, 0
    v_mov_b32 v101, 0
    v_dot2_f32_bf16 v100, v124, s40, v100
    v_dot2_f32_bf16 v101, v125, s40, v101
    v_dot2_f32_bf16 v100, v126, s40, v100
    v_dot2_f32_bf16 v101, v127, s40, v101
    v_dot2_f32_bf16 v100, v128, s40, v100
    v_dot2_f32_bf16 v101, v129, s40, v101
    v_dot2_f32_bf16 v100, v130, s40, v100
    v_dot2_f32_bf16 v101, v131, s40, v101
    v_dot2_f32_bf16 v100, v132, s40, v100
    v_dot2_f32_bf16 v101, v133, s40, v101
    v_dot2_f32_bf16 v100, v134, s40, v100
    v_dot2_f32_bf16 v101, v135, s40, v101
    v_dot2_f32_bf16 v100, v136, s40, v100
    v_dot2_f32_bf16 v101, v137, s40, v101
    v_dot2_f32_bf16 v100, v138, s40, v100
    v_dot2_f32_bf16 v101, v139, s40, v101
    v_dot2_f32_bf16 v100, v140, s40, v100
    v_dot2_f32_bf16 v101, v141, s40, v101
    v_dot2_f32_bf16 v100, v142, s40, v100
    v_dot2_f32_bf16 v101, v143, s40, v101
    v_dot2_f32_bf16 v100, v144, s40, v100
    v_dot2_f32_bf16 v101, v145, s40, v101
    v_dot2_f32_bf16 v100, v146, s40, v100
    v_dot2_f32_bf16 v101, v147, s40, v101
    v_dot2_f32_bf16 v100, v148, s40, v100
    v_dot2_f32_bf16 v101, v149, s40, v101
    v_dot2_f32_bf16 v100, v150, s40, v100
    v_dot2_f32_bf16 v101, v151, s40, v101
    v_dot2_f32_bf16 v100, v152, s40, v100
    v_dot2_f32_bf16 v101, v153, s40, v101
    v_dot2_f32_bf16 v100, v154, s40, v100
    v_dot2_f32_bf16 v101, v155, s40, v101
    v_dot2_f32_bf16 v100, v156, s40, v100
    v_dot2_f32_bf16 v101, v157, s40, v101
    v_dot2_f32_bf16 v100, v158, s40, v100
    v_dot2_f32_bf16 v101, v159, s40, v101
    v_dot2_f32_bf16 v100, v160, s40, v100
    v_dot2_f32_bf16 v101, v161, s40, v101
    v_dot2_f32_bf16 v100, v162, s40, v100
    v_dot2_f32_bf16 v101, v163, s40, v101
    v_dot2_f32_bf16 v100, v164, s40, v100
    v_dot2_f32_bf16 v101, v165, s40, v101
    v_dot2_f32_bf16 v100, v166, s40, v100
    v_dot2_f32_bf16 v101, v167, s40, v101
    v_dot2_f32_bf16 v100, v168, s40, v100
    v_dot2_f32_bf16 v101, v169, s40, v101
    v_dot2_f32_bf16 v100, v170, s40, v100
    v_dot2_f32_bf16 v101, v171, s40, v101
    v_dot2_f32_bf16 v100, v172, s40, v100
    v_dot2_f32_bf16 v101, v173, s40, v101
    v_dot2_f32_bf16 v100, v174, s40, v100
    v_dot2_f32_bf16 v101, v175, s40, v101
    v_dot2_f32_bf16 v100, v176, s40, v100
    v_dot2_f32_bf16 v101, v177, s40, v101
    v_dot2_f32_bf16 v100, v178, s40, v100
    v_dot2_f32_bf16 v101, v179, s40, v101
    v_dot2_f32_bf16 v100, v180, s40, v100
    v_dot2_f32_bf16 v101, v181, s40, v101
    v_dot2_f32_bf16 v100, v182, s40, v100
    v_dot2_f32_bf16 v101, v183, s40, v101
    v_dot2_f32_bf16 v100, v184, s40, v100
    v_dot2_f32_bf16 v101, v185, s40, v101
    v_dot2_f32_bf16 v100, v186, s40, v100
    v_dot2_f32_bf16 v101, v187, s40, v101
    v_dot2_f32_bf16 v100, v188, s40, v100
    v_dot2_f32_bf16 v101, v189, s40, v101
    v_dot2_f32_bf16 v100, v190, s40, v100
    v_dot2_f32_bf16 v101, v191, s40, v101
    v_dot2_f32_bf16 v100, v192, s40, v100
    v_dot2_f32_bf16 v101, v193, s40, v101
    v_dot2_f32_bf16 v100, v194, s40, v100
    v_dot2_f32_bf16 v101, v195, s40, v101
    v_dot2_f32_bf16 v100, v196, s40, v100
    v_dot2_f32_bf16 v101, v197, s40, v101
    v_dot2_f32_bf16 v100, v198, s40, v100
    v_dot2_f32_bf16 v101, v199, s40, v101
    v_dot2_f32_bf16 v100, v200, s40, v100
    v_dot2_f32_bf16 v101, v201, s40, v101
    v_dot2_f32_bf16 v100, v202, s40, v100
    v_dot2_f32_bf16 v101, v203, s40, v101
    v_dot2_f32_bf16 v100, v204, s40, v100
    v_dot2_f32_bf16 v101, v205, s40, v101
    v_dot2_f32_bf16 v100, v206, s40, v100
    v_dot2_f32_bf16 v101, v207, s40, v101
    v_dot2_f32_bf16 v100, v208, s40, v100
    v_dot2_f32_bf16 v101, v209, s40, v101
    v_dot2_f32_bf16 v100, v210, s40, v100
    v_dot2_f32_bf16 v101, v211, s40, v101
    v_dot2_f32_bf16 v100, v212, s40, v100
    v_dot2_f32_bf16 v101, v213, s40, v101
    v_dot2_f32_bf16 v100, v214, s40, v100
    v_dot2_f32_bf16 v101, v215, s40, v101
    v_dot2_f32_bf16 v100, v216, s40, v100
    v_dot2_f32_bf16 v101, v217, s40, v101
    v_dot2_f32_bf16 v100, v218, s40, v100
    v_dot2_f32_bf16 v101, v219, s40, v101
    v_dot2_f32_bf16 v100, v220, s40, v100
    v_dot2_f32_bf16 v101, v221, s40, v101
    v_dot2_f32_bf16 v100, v222, s40, v100
    v_dot2_f32_bf16 v101, v223, s40, v101
    v_dot2_f32_bf16 v100, v224, s40, v100
    v_dot2_f32_bf16 v101, v225, s40, v101
    v_dot2_f32_bf16 v100, v226, s40, v100
    v_dot2_f32_bf16 v101, v227, s40, v101
    v_dot2_f32_bf16 v100, v228, s40, v100
    v_dot2_f32_bf16 v101, v229, s40, v101
    v_dot2_f32_bf16 v100, v230, s40, v100
    v_dot2_f32_bf16 v101, v231, s40, v101
    v_dot2_f32_bf16 v100, v232, s40, v100
    v_dot2_f32_bf16 v101, v233, s40, v101
    v_dot2_f32_bf16 v100, v234, s40, v100
    v_dot2_f32_bf16 v101, v235, s40, v101
    v_dot2_f32_bf16 v100, v236, s40, v100
    v_dot2_f32_bf16 v101, v237, s40, v101
    v_dot2_f32_bf16 v100, v238, s40, v100
    v_dot2_f32_bf16 v101, v239, s40, v101
    v_dot2_f32_bf16 v100, v240, s40, v100
    v_dot2_f32_bf16 v101, v241, s40, v101
    v_dot2_f32_bf16 v100, v242, s40, v100
    v_dot2_f32_bf16 v101, v243, s40, v101
    v_dot2_f32_bf16 v100, v244, s40, v100
    v_dot2_f32_bf16 v101, v245, s40, v101
    v_dot2_f32_bf16 v100, v246, s40, v100
    v_dot2_f32_bf16 v101, v247, s40, v101
    v_dot2_f32_bf16 v100, v248, s40, v100
    v_dot2_f32_bf16 v101, v249, s40, v101
    v_dot2_f32_bf16 v100, v250, s40, v100
    v_dot2_f32_bf16 v101, v251, s40, v101
    s_nop 2
    v_add_f32 v100, v100, v101
    v_mov_b32 v101, v100
    s_nop 1
    v_permlane32_swap_b32 v100, v101
    s_nop 1
    v_add_f32 v100, v100, v101
    v_cvt_pk_bf16_f32 v101, v100, v100
    v_lshlrev_b32 v101, 16, v101
    v_sub_f32 v100, v100, v101
    v_cvt_pk_bf16_f32 v102, v100, v100
    v_lshlrev_b32 v102, 16, v102
    v_sub_f32 v100, v100, v102
    v_cvt_pk_bf16_f32 v101, v101, v102
    v_lshlrev_b32 v117, 16, v117
    v_cvt_pk_bf16_f32 v102, v100, v117
    v_bfe_u32 v103, v0, 5, 1
    v_cmp_eq_u32 vcc, 0, v103
    v_mov_b32 v254, 0
    v_mov_b32 v255, 0
    v_cndmask_b32 v252, 0, v101, vcc
    v_cndmask_b32 v253, 0, v102, vcc
L_cv_nx:
    v_bfe_u32 v9, v0, 3, 3
    v_bfe_u32 v4, v0, 4, 1
    v_lshlrev_b32 v4, 2, v4
    v_and_b32 v3, 7, v0
    v_xor_b32 v3, v3, v4
    v_lshlrev_b32 v3, 4, v3
    v_lshl_add_u32 v3, v9, 12, v3
    s_lshl_b32 s40, s31, 8
    s_add_u32 s40, s40, s36
    s_lshl_b32 s41, s3, 17
    s_add_u32 s40, s40, s41
    s_lshl_b32 s41, s3, 12
    v_bfe_u32 v4, v0, 2, 2
    v_and_b32 v5, 3, v0
    v_bfe_u32 v6, v0, 4, 1
    v_bfe_u32 v7, v0, 5, 1
    v_lshl_add_u32 v8, v7, 3, v4
    v_lshlrev_b32 v8, 7, v8
    v_lshl_add_u32 v8, v6, 5, v8
    v_lshl_add_u32 v8, v5, 3, v8
    v_lshrrev_b32 v9, 1, v4
    v_lshl_add_u32 v10, v9, 6, v8
    v_xor_b32 v11, 64, v10
    v_add_u32 v12, 0x10000, v10
    v_add_u32 v13, 0x10000, v11
    s_mul_i32 s43, s31, 458752
    s_lshl_b32 s44, s32, 2
    s_add_u32 s44, s44, s3
    s_mul_i32 s45, s44, 4682
    s_lshr_b32 s45, s45, 16
    s_mul_i32 s45, s45, 0
    s_lshl_b32 s44, s44, 11
    s_add_u32 s44, s44, s45
    s_add_u32 s44, s44, s43
    s_add_u32 s44, s44, s37
    s_add_u32 s45, s44, 114688
    s_add_u32 s46, s44, 229376
    s_add_u32 s47, s44, 344064
    v_and_b32 v15, 31, v0
    v_lshlrev_b32 v15, 2, v15
    s_lshl_b32 s48, s31, 9
    s_add_u32 s48, s48, s38
    v_cmp_eq_u32 s[14:15], 0, v7
    s_mov_b32 s12, 0x01000100
    v_mul_u32_u24 v118, 64, v0
    s_mov_b32 s54, 0x180a000
L_sp_1:
    s_sub_u32 s30, s30, 1
    s_cbranch_scc0 L_sp_1c
    s_mov_b32 s30, 0
    s_branch L_sp_1x
L_sp_1c:
    buffer_load_dword v119, v118, s[8:11], s54 offen sc1
    s_waitcnt vmcnt(0)
    v_cmpx_gt_u32 s[52:53], s39, v119
    s_cbranch_execnz L_sp_1
L_sp_1x:
    s_mov_b64 exec, -1
    s_barrier
    s_cmp_ge_u32 s2, 224
    s_cbranch_scc1 L_stats
    s_add_u32 m0, s41, 0
    s_add_u32 s42, s40, 0
    buffer_load_dwordx4 v3, s[8:11], s42 offen sc1 lds
    s_add_u32 m0, s41, 1024
    s_add_u32 s42, s40, 32768
    buffer_load_dwordx4 v3, s[8:11], s42 offen sc1 lds
    s_add_u32 m0, s41, 2048
    s_add_u32 s42, s40, 65536
    buffer_load_dwordx4 v3, s[8:11], s42 offen sc1 lds
    s_add_u32 m0, s41, 3072
    s_add_u32 s42, s40, 98304
    buffer_load_dwordx4 v3, s[8:11], s42 offen sc1 lds
    s_add_u32 m0, s41, 16384
    s_add_u32 s42, s40, 524288
    buffer_load_dwordx4 v3, s[8:11], s42 offen sc1 lds
    s_add_u32 m0, s41, 17408
    s_add_u32 s42, s40, 557056
    buffer_load_dwordx4 v3, s[8:11], s42 offen sc1 lds
    s_add_u32 m0, s41, 18432
    s_add_u32 s42, s40, 589824
    buffer_load_dwordx4 v3, s[8:11], s42 offen sc1 lds
    s_add_u32 m0, s41, 19456
    s_add_u32 s42, s40, 622592
    buffer_load_dwordx4 v3, s[8:11], s42 offen sc1 lds
    s_add_u32 m0, s41, 32768
    s_add_u32 s42, s40, 1048576
    buffer_load_dwordx4 v3, s[8:11], s42 offen sc1 lds
    s_add_u32 m0, s41, 33792
    s_add_u32 s42, s40, 1081344
    buffer_load_dwordx4 v3, s[8:11], s42 offen sc1 lds
    s_add_u32 m0, s41, 34816
    s_add_u32 s42, s40, 1114112
    buffer_load_dwordx4 v3, s[8:11], s42 offen sc1 lds
    s_add_u32 m0, s41, 35840
    s_add_u32 s42, s40, 1146880
    buffer_load_dwordx4 v3, s[8:11], s42 offen sc1 lds
    s_add_u32 m0, s41, 49152
    s_add_u32 s42, s40, 1572864
    buffer_load_dwordx4 v3, s[8:11], s42 offen sc1 lds
    s_waitcnt vmcnt(9)
    s_barrier
    ds_read_b64_tr_b16 v[16:17], v10 offset:0
    ds_read_b64_tr_b16 v[18:19], v10 offset:512
    ds_read_b64_tr_b16 v[20:21], v11 offset:0
    ds_read_b64_tr_b16 v[22:23], v11 offset:512
    ds_read_b64_tr_b16 v[96:97], v10 offset:2048
    ds_read_b64_tr_b16 v[98:99], v10 offset:2560
    ds_read_b64_tr_b16 v[100:101], v11 offset:2048
    ds_read_b64_tr_b16 v[102:103], v11 offset:2560
    s_waitcnt lgkmcnt(4)
    v_mfma_f32_32x32x16_bf16 v[32:47], v[124:127], v[16:19], 0
    ds_read_b64_tr_b16 v[24:25], v10 offset:4096
    ds_read_b64_tr_b16 v[26:27], v10 offset:4608
    v_mfma_f32_32x32x16_bf16 v[48:63], v[124:127], v[20:23], 0
    ds_read_b64_tr_b16 v[28:29], v11 offset:4096
    ds_read_b64_tr_b16 v[30:31], v11 offset:4608
    s_add_u32 m0, s41, 50176
    s_add_u32 s42, s40, 1605632
    buffer_load_dwordx4 v3, s[8:11], s42 offen sc1 lds
    s_waitcnt lgkmcnt(4)
    v_mfma_f32_32x32x16_bf16 v[32:47], v[128:131], v[96:99], v[32:47]
    ds_read_b64_tr_b16 v[16:17], v10 offset:6144
    ds_read_b64_tr_b16 v[18:19], v10 offset:6656
    v_mfma_f32_32x32x16_bf16 v[48:63], v[128:131], v[100:103], v[48:63]
    ds_read_b64_tr_b16 v[20:21], v11 offset:6144
    ds_read_b64_tr_b16 v[22:23], v11 offset:6656
    s_add_u32 m0, s41, 51200
    s_add_u32 s42, s40, 1638400
    buffer_load_dwordx4 v3, s[8:11], s42 offen sc1 lds
    s_waitcnt lgkmcnt(4)
    v_mfma_f32_32x32x16_bf16 v[32:47], v[132:135], v[24:27], v[32:47]
    ds_read_b64_tr_b16 v[96:97], v10 offset:8192
    ds_read_b64_tr_b16 v[98:99], v10 offset:8704
    v_mfma_f32_32x32x16_bf16 v[48:63], v[132:135], v[28:31], v[48:63]
    ds_read_b64_tr_b16 v[100:101], v11 offset:8192
    ds_read_b64_tr_b16 v[102:103], v11 offset:8704
    s_add_u32 m0, s41, 52224
    s_add_u32 s42, s40, 1671168
    buffer_load_dwordx4 v3, s[8:11], s42 offen sc1 lds
    s_waitcnt lgkmcnt(4)
    v_mfma_f32_32x32x16_bf16 v[32:47], v[136:139], v[16:19], v[32:47]
    ds_read_b64_tr_b16 v[24:25], v10 offset:10240
    ds_read_b64_tr_b16 v[26:27], v10 offset:10752
    v_mfma_f32_32x32x16_bf16 v[48:63], v[136:139], v[20:23], v[48:63]
    ds_read_b64_tr_b16 v[28:29], v11 offset:10240
    ds_read_b64_tr_b16 v[30:31], v11 offset:10752
    s_waitcnt lgkmcnt(4)
    v_mfma_f32_32x32x16_bf16 v[32:47], v[140:143], v[96:99], v[32:47]
    ds_read_b64_tr_b16 v[16:17], v10 offset:12288
    ds_read_b64_tr_b16 v[18:19], v10 offset:12800
    v_mfma_f32_32x32x16_bf16 v[48:63], v[140:143], v[100:103], v[48:63]
    ds_read_b64_tr_b16 v[20:21], v11 offset:12288
    ds_read_b64_tr_b16 v[22:23], v11 offset:12800
    s_add_u32 m0, s41, 65536
    s_add_u32 s42, s40, 128
    buffer_load_dwordx4 v3, s[8:11], s42 offen sc1 lds
    s_waitcnt lgkmcnt(4)
    v_mfma_f32_32x32x16_bf16 v[32:47], v[144:147], v[24:27], v[32:47]
    ds_read_b64_tr_b16 v[96:97], v10 offset:14336
    ds_read_b64_tr_b16 v[98:99], v10 offset:14848
    v_mfma_f32_32x32x16_bf16 v[48:63], v[144:147], v[28:31], v[48:63]
    ds_read_b64_tr_b16 v[100:101], v11 offset:14336
    ds_read_b64_tr_b16 v[102:103], v11 offset:14848
    s_waitcnt vmcnt(9)
    s_barrier
    s_waitcnt lgkmcnt(4)
    v_mfma_f32_32x32x16_bf16 v[32:47], v[148:151], v[16:19], v[32:47]
    ds_read_b64_tr_b16 v[24:25], v10 offset:16384
    ds_read_b64_tr_b16 v[26:27], v10 offset:16896
    v_mfma_f32_32x32x16_bf16 v[48:63], v[148:151], v[20:23], v[48:63]
    ds_read_b64_tr_b16 v[28:29], v11 offset:16384
    ds_read_b64_tr_b16 v[30:31], v11 offset:16896
    s_add_u32 m0, s41, 66560
    s_add_u32 s42, s40, 32896
    buffer_load_dwordx4 v3, s[8:11], s42 offen sc1 lds
    s_waitcnt lgkmcnt(4)
    v_mfma_f32_32x32x16_bf16 v[32:47], v[152:155], v[96:99], v[32:47]
    ds_read_b64_tr_b16 v[16:17], v10 offset:18432
    ds_read_b64_tr_b16 v[18:19], v10 offset:18944
    v_mfma_f32_32x32x16_bf16 v[48:63], v[152:155], v[100:103], v[48:63]
    ds_read_b64_tr_b16 v[20:21], v11 offset:18432
    ds_read_b64_tr_b16 v[22:23], v11 offset:18944
    s_waitcnt lgkmcnt(4)
    v_mfma_f32_32x32x16_bf16 v[32:47], v[156:159], v[24:27], v[32:47]
    ds_read_b64_tr_b16 v[96:97], v10 offset:20480
    ds_read_b64_tr_b16 v[98:99], v10 offset:20992
    v_mfma_f32_32x32x16_bf16 v[48:63], v[156:159], v[28:31], v[48:63]
    ds_read_b64_tr_b16 v[100:101], v11 offset:20480
    ds_read_b64_tr_b16 v[102:103], v11 offset:20992
    s_add_u32 m0, s41, 67584
    s_add_u32 s42, s40, 65664
    buffer_load_dwordx4 v3, s[8:11], s42 offen sc1 lds
    s_waitcnt lgkmcnt(4)
    v_mfma_f32_32x32x16_bf16 v[32:47], v[160:163], v[16:19], v[32:47]
    ds_read_b64_tr_b16 v[24:25], v10 offset:22528
    ds_read_b64_tr_b16 v[26:27], v10 offset:23040
    v_mfma_f32_32x32x16_bf16 v[48:63], v[160:163], v[20:23], v[48:63]
    ds_read_b64_tr_b16 v[28:29], v11 offset:22528
    ds_read_b64_tr_b16 v[30:31], v11 offset:23040
    s_waitcnt lgkmcnt(4)
    v_mfma_f32_32x32x16_bf16 v[32:47], v[164:167], v[96:99], v[32:47]
    ds_read_b64_tr_b16 v[16:17], v10 offset:24576
    ds_read_b64_tr_b16 v[18:19], v10 offset:25088
    v_mfma_f32_32x32x16_bf16 v[48:63], v[164:167], v[100:103], v[48:63]
    ds_read_b64_tr_b16 v[20:21], v11 offset:24576
    ds_read_b64_tr_b16 v[22:23], v11 offset:25088
    s_add_u32 m0, s41, 68608
    s_add_u32 s42, s40, 98432
    buffer_load_dwordx4 v3, s[8:11], s42 offen sc1 lds
    s_waitcnt lgkmcnt(4)
    v_mfma_f32_32x32x16_bf16 v[32:47], v[168:171], v[24:27], v[32:47]
    ds_read_b64_tr_b16 v[96:97], v10 offset:26624
    ds_read_b64_tr_b16 v[98:99], v10 offset:27136
    v_mfma_f32_32x32x16_bf16 v[48:63], v[168:171], v[28:31], v[48:63]
    ds_read_b64_tr_b16 v[100:101], v11 offset:26624
    ds_read_b64_tr_b16 v[102:103], v11 offset:27136
    s_waitcnt lgkmcnt(4)
    v_mfma_f32_32x32x16_bf16 v[32:47], v[172:175], v[16:19], v[32:47]
    ds_read_b64_tr_b16 v[24:25], v10 offset:28672
    ds_read_b64_tr_b16 v[26:27], v10 offset:29184
    v_mfma_f32_32x32x16_bf16 v[48:63], v[172:175], v[20:23], v[48:63]
    ds_read_b64_tr_b16 v[28:29], v11 offset:28672
    ds_read_b64_tr_b16 v[30:31], v11 offset:29184
    s_add_u32 m0, s41, 81920
    s_add_u32 s42, s40, 524416
    buffer_load_dwordx4 v3, s[8:11], s42 offen sc1 lds
    s_waitcnt lgkmcnt(4)
    v_mfma_f32_32x32x16_bf16 v[32:47], v[176:179], v[96:99], v[32:47]
    ds_read_b64_tr_b16 v[16:17], v10 offset:30720
    ds_read_b64_tr_b16 v[18:19], v10 offset:31232
    v_mfma_f32_32x32x16_bf16 v[48:63], v[176:179], v[100:103], v[48:63]
    ds_read_b64_tr_b16 v[20:21], v11 offset:30720
    ds_read_b64_tr_b16 v[22:23], v11 offset:31232
    s_waitcnt vmcnt(9)
    s_barrier
    s_waitcnt lgkmcnt(4)
    v_mfma_f32_32x32x16_bf16 v[32:47], v[180:183], v[24:27], v[32:47]
    ds_read_b64_tr_b16 v[96:97], v10 offset:32768
    ds_read_b64_tr_b16 v[98:99], v10 offset:33280
    v_mfma_f32_32x32x16_bf16 v[48:63], v[180:183], v[28:31], v[48:63]
    ds_read_b64_tr_b16 v[100:101], v11 offset:32768
    ds_read_b64_tr_b16 v[102:103], v11 offset:33280
    s_add_u32 m0, s41, 82944
    s_add_u32 s42, s40, 557184
    buffer_load_dwordx4 v3, s[8:11], s42 offen sc1 lds
    s_waitcnt lgkmcnt(4)
    v_mfma_f32_32x32x16_bf16 v[32:47], v[184:187], v[16:19], v[32:47]
    ds_read_b64_tr_b16 v[24:25], v10 offset:34816
    ds_read_b64_tr_b16 v[26:27], v10 offset:35328
    v_mfma_f32_32x32x16_bf16 v[48:63], v[184:187], v[20:23], v[48:63]
    ds_read_b64_tr_b16 v[28:29], v11 offset:34816
    ds_read_b64_tr_b16 v[30:31], v11 offset:35328
    s_waitcnt lgkmcnt(4)
    v_mfma_f32_32x32x16_bf16 v[32:47], v[188:191], v[96:99], v[32:47]
    ds_read_b64_tr_b16 v[16:17], v10 offset:36864
    ds_read_b64_tr_b16 v[18:19], v10 offset:37376
    v_mfma_f32_32x32x16_bf16 v[48:63], v[188:191], v[100:103], v[48:63]
    ds_read_b64_tr_b16 v[20:21], v11 offset:36864
    ds_read_b64_tr_b16 v[22:23], v11 offset:37376
    s_add_u32 m0, s41, 83968
    s_add_u32 s42, s40, 589952
    buffer_load_dwordx4 v3, s[8:11], s42 offen sc1 lds
    s_waitcnt lgkmcnt(4)
    v_mfma_f32_32x32x16_bf16 v[32:47], v[192:195], v[24:27], v[32:47]
    ds_read_b64_tr_b16 v[96:97], v10 offset:38912
    ds_read_b64_tr_b16 v[98:99], v10 offset:39424
    v_mfma_f32_32x32x16_bf16 v[48:63], v[192:195], v[28:31], v[48:63]
    ds_read_b64_tr_b16 v[100:101], v11 offset:38912
    ds_read_b64_tr_b16 v[102:103], v11 offset:39424
    s_waitcnt lgkmcnt(4)
    v_mfma_f32_32x32x16_bf16 v[32:47], v[196:199], v[16:19], v[32:47]
    ds_read_b64_tr_b16 v[24:25], v10 offset:40960
    ds_read_b64_tr_b16 v[26:27], v10 offset:41472
    v_mfma_f32_32x32x16_bf16 v[48:63], v[196:199], v[20:23], v[48:63]
    ds_read_b64_tr_b16 v[28:29], v11 offset:40960
    ds_read_b64_tr_b16 v[30:31], v11 offset:41472
    s_add_u32 m0, s41, 84992
    s_add_u32 s42, s40, 622720
    buffer_load_dwordx4 v3, s[8:11], s42 offen sc1 lds
    s_waitcnt lgkmcnt(4)
    v_mfma_f32_32x32x16_bf16 v[32:47], v[200:203], v[96:99], v[32:47]
    ds_read_b64_tr_b16 v[16:17], v10 offset:43008
    ds_read_b64_tr_b16 v[18:19], v10 offset:43520
    v_mfma_f32_32x32x16_bf16 v[48:63], v[200:203], v[100:103], v[48:63]
    ds_read_b64_tr_b16 v[20:21], v11 offset:43008
    ds_read_b64_tr_b16 v[22:23], v11 offset:43520
    s_waitcnt lgkmcnt(4)
    v_mfma_f32_32x32x16_bf16 v[32:47], v[204:207], v[24:27], v[32:47]
    ds_read_b64_tr_b16 v[96:97], v10 offset:45056
    ds_read_b64_tr_b16 v[98:99], v10 offset:45568
    v_mfma_f32_32x32x16_bf16 v[48:63], v[204:207], v[28:31], v[48:63]
    ds_read_b64_tr_b16 v[100:101], v11 offset:45056
    ds_read_b64_tr_b16 v[102:103], v11 offset:45568
    s_add_u32 m0, s41, 98304
    s_add_u32 s42, s40, 1048704
    buffer_load_dwordx4 v3, s[8:11], s42 offen sc1 lds
    s_waitcnt lgkmcnt(4)
    v_mfma_f32_32x32x16_bf16 v[32:47], v[208:211], v[16:19], v[32:47]
    ds_read_b64_tr_b16 v[24:25], v10 offset:47104
    ds_read_b64_tr_b16 v[26:27], v10 offset:47616
    v_mfma_f32_32x32x16_bf16 v[48:63], v[208:211], v[20:23], v[48:63]
    ds_read_b64_tr_b16 v[28:29], v11 offset:47104
    ds_read_b64_tr_b16 v[30:31], v11 offset:47616
    s_waitcnt vmcnt(9)
    s_barrier
    s_waitcnt lgkmcnt(4)
    v_mfma_f32_32x32x16_bf16 v[32:47], v[212:215], v[96:99], v[32:47]
    ds_read_b64_tr_b16 v[16:17], v10 offset:49152
    ds_read_b64_tr_b16 v[18:19], v10 offset:49664
    v_mfma_f32_32x32x16_bf16 v[48:63], v[212:215], v[100:103], v[48:63]
    ds_read_b64_tr_b16 v[20:21], v11 offset:49152
    ds_read_b64_tr_b16 v[22:23], v11 offset:49664
    s_add_u32 m0, s41, 99328
    s_add_u32 s42, s40, 1081472
    buffer_load_dwordx4 v3, s[8:11], s42 offen sc1 lds
    s_waitcnt lgkmcnt(4)
    v_mfma_f32_32x32x16_bf16 v[32:47], v[216:219], v[24:27], v[32:47]
    ds_read_b64_tr_b16 v[96:97], v10 offset:51200
    ds_read_b64_tr_b16 v[98:99], v10 offset:51712
    v_mfma_f32_32x32x16_bf16 v[48:63], v[216:219], v[28:31], v[48:63]
    ds_read_b64_tr_b16 v[100:101], v11 offset:51200
    ds_read_b64_tr_b16 v[102:103], v11 offset:51712
    s_waitcnt lgkmcnt(4)
    v_mfma_f32_32x32x16_bf16 v[32:47], v[220:223], v[16:19], v[32:47]
    ds_read_b64_tr_b16 v[24:25], v10 offset:53248
    ds_read_b64_tr_b16 v[26:27], v10 offset:53760
    v_mfma_f32_32x32x16_bf16 v[48:63], v[220:223], v[20:23], v[48:63]
    ds_read_b64_tr_b16 v[28:29], v11 offset:53248
    ds_read_b64_tr_b16 v[30:31], v11 offset:53760
    s_add_u32 m0, s41, 100352
    s_add_u32 s42, s40, 1114240
    buffer_load_dwordx4 v3, s[8:11], s42 offen sc1 lds
    s_waitcnt lgkmcnt(4)
    v_mfma_f32_32x32x16_bf16 v[32:47], v[224:227], v[96:99], v[32:47]
    ds_read_b64_tr_b16 v[16:17], v10 offset:55296
    ds_read_b64_tr_b16 v[18:19], v10 offset:55808
    v_mfma_f32_32x32x16_bf16 v[48:63], v[224:227], v[100:103], v[48:63]
    ds_read_b64_tr_b16 v[20:21], v11 offset:55296
    ds_read_b64_tr_b16 v[22:23], v11 offset:55808
    s_waitcnt lgkmcnt(4)
    v_mfma_f32_32x32x16_bf16 v[32:47], v[228:231], v[24:27], v[32:47]
    ds_read_b64_tr_b16 v[96:97], v10 offset:57344
    ds_read_b64_tr_b16 v[98:99], v10 offset:57856
    v_mfma_f32_32x32x16_bf16 v[48:63], v[228:231], v[28:31], v[48:63]
    ds_read_b64_tr_b16 v[100:101], v11 offset:57344
    ds_read_b64_tr_b16 v[102:103], v11 offset:57856
    s_add_u32 m0, s41, 101376
    s_add_u32 s42, s40, 1147008
    buffer_load_dwordx4 v3, s[8:11], s42 offen sc1 lds
    s_waitcnt lgkmcnt(4)
    v_mfma_f32_32x32x16_bf16 v[32:47], v[232:235], v[16:19], v[32:47]
    ds_read_b64_tr_b16 v[24:25], v10 offset:59392
    ds_read_b64_tr_b16 v[26:27], v10 offset:59904
    v_mfma_f32_32x32x16_bf16 v[48:63], v[232:235], v[20:23], v[48:63]
    ds_read_b64_tr_b16 v[28:29], v11 offset:59392
    ds_read_b64_tr_b16 v[30:31], v11 offset:59904
    s_waitcnt lgkmcnt(4)
    v_mfma_f32_32x32x16_bf16 v[32:47], v[236:239], v[96:99], v[32:47]
    ds_read_b64_tr_b16 v[16:17], v10 offset:61440
    ds_read_b64_tr_b16 v[18:19], v10 offset:61952
    v_mfma_f32_32x32x16_bf16 v[48:63], v[236:239], v[100:103], v[48:63]
    ds_read_b64_tr_b16 v[20:21], v11 offset:61440
    ds_read_b64_tr_b16 v[22:23], v11 offset:61952
    s_add_u32 m0, s41, 114688
    s_add_u32 s42, s40, 1572992
    buffer_load_dwordx4 v3, s[8:11], s42 offen sc1 lds
    s_waitcnt lgkmcnt(4)
    v_mfma_f32_32x32x16_bf16 v[32:47], v[240:243], v[24:27], v[32:47]
    ds_read_b64_tr_b16 v[96:97], v10 offset:63488
    ds_read_b64_tr_b16 v[98:99], v10 offset:64000
    v_mfma_f32_32x32x16_bf16 v[48:63], v[240:243], v[28:31], v[48:63]
    ds_read_b64_tr_b16 v[100:101], v11 offset:63488
    ds_read_b64_tr_b16 v[102:103], v11 offset:64000
    s_waitcnt vmcnt(9)
    s_barrier
    s_waitcnt lgkmcnt(4)
    v_mfma_f32_32x32x16_bf16 v[32:47], v[244:247], v[16:19], v[32:47]
    ds_read_b64_tr_b16 v[24:25], v12 offset:0
    ds_read_b64_tr_b16 v[26:27], v12 offset:512
    v_mfma_f32_32x32x16_bf16 v[48:63], v[244:247], v[20:23], v[48:63]
    ds_read_b64_tr_b16 v[28:29], v13 offset:0
    ds_read_b64_tr_b16 v[30:31], v13 offset:512
    s_add_u32 m0, s41, 115712
    s_add_u32 s42, s40, 1605760
    buffer_load_dwordx4 v3, s[8:11], s42 offen sc1 lds
    s_waitcnt lgkmcnt(4)
    v_mfma_f32_32x32x16_bf16 v[32:47], v[248:251], v[96:99], v[32:47]
    ds_read_b64_tr_b16 v[16:17], v12 offset:2048
    ds_read_b64_tr_b16 v[18:19], v12 offset:2560
    v_mfma_f32_32x32x16_bf16 v[48:63], v[248:251], v[100:103], v[48:63]
    ds_read_b64_tr_b16 v[20:21], v13 offset:2048
    ds_read_b64_tr_b16 v[22:23], v13 offset:2560
    buffer_load_dword v112, v15, s[8:11], s48 offen offset:0 sc1
    buffer_load_dword v113, v15, s[8:11], s48 offen offset:128 sc1
    s_waitcnt lgkmcnt(4)
    v_mfma_f32_32x32x16_bf16 v[64:79], v[124:127], v[24:27], 0
    ds_read_b64_tr_b16 v[96:97], v12 offset:4096
    ds_read_b64_tr_b16 v[98:99], v12 offset:4608
    v_mfma_f32_32x32x16_bf16 v[80:95], v[124:127], v[28:31], 0
    ds_read_b64_tr_b16 v[100:101], v13 offset:4096
    ds_read_b64_tr_b16 v[102:103], v13 offset:4608
    s_add_u32 m0, s41, 116736
    s_add_u32 s42, s40, 1638528
    buffer_load_dwordx4 v3, s[8:11], s42 offen sc1 lds
    s_waitcnt lgkmcnt(4)
    v_mfma_f32_32x32x16_bf16 v[64:79], v[128:131], v[16:19], v[64:79]
    ds_read_b64_tr_b16 v[24:25], v12 offset:6144
    ds_read_b64_tr_b16 v[26:27], v12 offset:6656
    v_mfma_f32_32x32x16_bf16 v[80:95], v[128:131], v[20:23], v[80:95]
    ds_read_b64_tr_b16 v[28:29], v13 offset:6144
    ds_read_b64_tr_b16 v[30:31], v13 offset:6656
    s_waitcnt lgkmcnt(4)
    v_mfma_f32_32x32x16_bf16 v[64:79], v[132:135], v[96:99], v[64:79]
    ds_read_b64_tr_b16 v[16:17], v12 offset:8192
    ds_read_b64_tr_b16 v[18:19], v12 offset:8704
    v_mfma_f32_32x32x16_bf16 v[80:95], v[132:135], v[100:103], v[80:95]
    ds_read_b64_tr_b16 v[20:21], v13 offset:8192
    ds_read_b64_tr_b16 v[22:23], v13 offset:8704
    s_add_u32 m0, s41, 117760
    s_add_u32 s42, s40, 1671296
    buffer_load_dwordx4 v3, s[8:11], s42 offen sc1 lds
    s_waitcnt lgkmcnt(4)
    v_mfma_f32_32x32x16_bf16 v[64:79], v[136:139], v[24:27], v[64:79]
    ds_read_b64_tr_b16 v[96:97], v12 offset:10240
    ds_read_b64_tr_b16 v[98:99], v12 offset:10752
    v_mfma_f32_32x32x16_bf16 v[80:95], v[136:139], v[28:31], v[80:95]
    ds_read_b64_tr_b16 v[100:101], v13 offset:10240
    ds_read_b64_tr_b16 v[102:103], v13 offset:10752
    s_waitcnt vmcnt(2)
    v_min_u32 v8, v112, v113
    v_cmp_eq_u32 s[52:53], 0, v8
    s_nop 0
    s_cmp_lg_u64 s[52:53], 0
    s_cbranch_scc1 L_lp_2
L_lk_3:
    v_cndmask_b32 v105, 0, v112, s[14:15]
    v_mov_b32 v106, 0
    v_mov_b32 v107, 0
    v_perm_b32 v104, v105, v105, s12
    v_cndmask_b32 v109, 0, v113, s[14:15]
    v_mov_b32 v110, 0
    v_mov_b32 v111, 0
    v_perm_b32 v108, v109, v109, s12
    s_nop 1
    v_mfma_f32_32x32x16_bf16 v[32:47], v[252:255], v[104:107], v[32:47]
    v_mfma_f32_32x32x16_bf16 v[48:63], v[252:255], v[108:111], v[48:63]
    s_waitcnt lgkmcnt(4)
    v_mfma_f32_32x32x16_bf16 v[64:79], v[140:143], v[16:19], v[64:79]
    ds_read_b64_tr_b16 v[24:25], v12 offset:12288
    ds_read_b64_tr_b16 v[26:27], v12 offset:12800
    v_mfma_f32_32x32x16_bf16 v[80:95], v[140:143], v[20:23], v[80:95]
    ds_read_b64_tr_b16 v[28:29], v13 offset:12288
    ds_read_b64_tr_b16 v[30:31], v13 offset:12800
    s_waitcnt lgkmcnt(4)
    v_mfma_f32_32x32x16_bf16 v[64:79], v[144:147], v[96:99], v[64:79]
    ds_read_b64_tr_b16 v[16:17], v12 offset:14336
    ds_read_b64_tr_b16 v[18:19], v12 offset:14848
    v_mfma_f32_32x32x16_bf16 v[80:95], v[144:147], v[100:103], v[80:95]
    ds_read_b64_tr_b16 v[20:21], v13 offset:14336
    ds_read_b64_tr_b16 v[22:23], v13 offset:14848
    s_waitcnt vmcnt(10)
    s_barrier
    s_waitcnt lgkmcnt(4)
    v_mfma_f32_32x32x16_bf16 v[64:79], v[148:151], v[24:27], v[64:79]
    ds_read_b64_tr_b16 v[96:97], v12 offset:16384
    ds_read_b64_tr_b16 v[98:99], v12 offset:16896
    v_max_f32 v8, 0, v32
    v_max_f32 v9, 0, v33
    v_mul_f32 v32, v8, v32
    v_mfma_f32_32x32x16_bf16 v[80:95], v[148:151], v[28:31], v[80:95]
    ds_read_b64_tr_b16 v[100:101], v13 offset:16384
    ds_read_b64_tr_b16 v[102:103], v13 offset:16896
    v_mul_f32 v33, v9, v33
    v_cvt_pk_bf16_f32 v32, v32, v33
    v_max_f32 v8, 0, v34
    s_waitcnt lgkmcnt(4)
    v_mfma_f32_32x32x16_bf16 v[64:79], v[152:155], v[16:19], v[64:79]
    ds_read_b64_tr_b16 v[24:25], v12 offset:18432
    ds_read_b64_tr_b16 v[26:27], v12 offset:18944
    v_max_f32 v9, 0, v35
    v_mul_f32 v34, v8, v34
    v_mul_f32 v35, v9, v35
    v_mfma_f32_32x32x16_bf16 v[80:95], v[152:155], v[20:23], v[80:95]
    ds_read_b64_tr_b16 v[28:29], v13 offset:18432
    ds_read_b64_tr_b16 v[30:31], v13 offset:18944
    v_cvt_pk_bf16_f32 v33, v34, v35
    v_max_f32 v8, 0, v36
    v_max_f32 v9, 0, v37
    s_waitcnt lgkmcnt(4)
    v_mfma_f32_32x32x16_bf16 v[64:79], v[156:159], v[96:99], v[64:79]
    ds_read_b64_tr_b16 v[16:17], v12 offset:20480
    ds_read_b64_tr_b16 v[18:19], v12 offset:20992
    v_mul_f32 v36, v8, v36
    v_mul_f32 v37, v9, v37
    v_cvt_pk_bf16_f32 v34, v36, v37
    v_mfma_f32_32x32x16_bf16 v[80:95], v[156:159], v[100:103], v[80:95]
    ds_read_b64_tr_b16 v[20:21], v13 offset:20480
    ds_read_b64_tr_b16 v[22:23], v13 offset:20992
    v_max_f32 v8, 0, v38
    v_max_f32 v9, 0, v39
    v_mul_f32 v38, v8, v38
    s_waitcnt lgkmcnt(4)
    v_mfma_f32_32x32x16_bf16 v[64:79], v[160:163], v[24:27], v[64:79]
    ds_read_b64_tr_b16 v[96:97], v12 offset:22528
    ds_read_b64_tr_b16 v[98:99], v12 offset:23040
    v_mul_f32 v39, v9, v39
    v_cvt_pk_bf16_f32 v35, v38, v39
    buffer_store_dwordx4 v[32:35], v116, s[8:11], s44 offen offset:0 sc1
    v_mfma_f32_32x32x16_bf16 v[80:95], v[160:163], v[28:31], v[80:95]
    ds_read_b64_tr_b16 v[100:101], v13 offset:22528
    ds_read_b64_tr_b16 v[102:103], v13 offset:23040
    v_max_f32 v8, 0, v40
    v_max_f32 v9, 0, v41
    v_mul_f32 v40, v8, v40
    s_waitcnt lgkmcnt(4)
    v_mfma_f32_32x32x16_bf16 v[64:79], v[164:167], v[16:19], v[64:79]
    ds_read_b64_tr_b16 v[24:25], v12 offset:24576
    ds_read_b64_tr_b16 v[26:27], v12 offset:25088
    v_mul_f32 v41, v9, v41
    v_cvt_pk_bf16_f32 v40, v40, v41
    v_max_f32 v8, 0, v42
    v_mfma_f32_32x32x16_bf16 v[80:95], v[164:167], v[20:23], v[80:95]
    ds_read_b64_tr_b16 v[28:29], v13 offset:24576
    ds_read_b64_tr_b16 v[30:31], v13 offset:25088
    v_max_f32 v9, 0, v43
    v_mul_f32 v42, v8, v42
    v_mul_f32 v43, v9, v43
    s_waitcnt lgkmcnt(4)
    v_mfma_f32_32x32x16_bf16 v[64:79], v[168:171], v[96:99], v[64:79]
    ds_read_b64_tr_b16 v[16:17], v12 offset:26624
    ds_read_b64_tr_b16 v[18:19], v12 offset:27136
    v_cvt_pk_bf16_f32 v41, v42, v43
    v_max_f32 v8, 0, v44
    v_max_f32 v9, 0, v45
    v_mfma_f32_32x32x16_bf16 v[80:95], v[168:171], v[100:103], v[80:95]
    ds_read_b64_tr_b16 v[20:21], v13 offset:26624
    ds_read_b64_tr_b16 v[22:23], v13 offset:27136
    v_mul_f32 v44, v8, v44
    v_mul_f32 v45, v9, v45
    v_cvt_pk_bf16_f32 v42, v44, v45
    s_waitcnt lgkmcnt(4)
    v_mfma_f32_32x32x16_bf16 v[64:79], v[172:175], v[24:27], v[64:79]
    ds_read_b64_tr_b16 v[96:97], v12 offset:28672
    ds_read_b64_tr_b16 v[98:99], v12 offset:29184
    v_max_f32 v8, 0, v46
    v_max_f32 v9, 0, v47
    v_mul_f32 v46, v8, v46
    v_mfma_f32_32x32x16_bf16 v[80:95], v[172:175], v[28:31], v[80:95]
    ds_read_b64_tr_b16 v[100:101], v13 offset:28672
    ds_read_b64_tr_b16 v[102:103], v13 offset:29184
    v_mul_f32 v47, v9, v47
    v_cvt_pk_bf16_f32 v43, v46, v47
    buffer_store_dwordx4 v[40:43], v116, s[8:11], s44 offen offset:1024 sc1
    s_waitcnt lgkmcnt(4)
    v_mfma_f32_32x32x16_bf16 v[64:79], v[176:179], v[16:19], v[64:79]
    ds_read_b64_tr_b16 v[24:25], v12 offset:30720
    ds_read_b64_tr_b16 v[26:27], v12 offset:31232
    v_max_f32 v8, 0, v48
    v_max_f32 v9, 0, v49
    v_mul_f32 v48, v8, v48
    v_mfma_f32_32x32x16_bf16 v[80:95], v[176:179], v[20:23], v[80:95]
    ds_read_b64_tr_b16 v[28:29], v13 offset:30720
    ds_read_b64_tr_b16 v[30:31], v13 offset:31232
    v_mul_f32 v49, v9, v49
    v_cvt_pk_bf16_f32 v48, v48, v49
    v_max_f32 v8, 0, v50
    s_waitcnt vmcnt(8)
    s_barrier
    s_waitcnt lgkmcnt(4)
    v_mfma_f32_32x32x16_bf16 v[64:79], v[180:183], v[96:99], v[64:79]
    ds_read_b64_tr_b16 v[16:17], v12 offset:32768
    ds_read_b64_tr_b16 v[18:19], v12 offset:33280
    v_max_f32 v9, 0, v51
    v_mul_f32 v50, v8, v50
    v_mul_f32 v51, v9, v51
    v_mfma_f32_32x32x16_bf16 v[80:95], v[180:183], v[100:103], v[80:95]
    ds_read_b64_tr_b16 v[20:21], v13 offset:32768
    ds_read_b64_tr_b16 v[22:23], v13 offset:33280
    v_cvt_pk_bf16_f32 v49, v50, v51
    v_max_f32 v8, 0, v52
    v_max_f32 v9, 0, v53
    s_waitcnt lgkmcnt(4)
    v_mfma_f32_32x32x16_bf16 v[64:79], v[184:187], v[24:27], v[64:79]
    ds_read_b64_tr_b16 v[96:97], v12 offset:34816
    ds_read_b64_tr_b16 v[98:99], v12 offset:35328
    v_mul_f32 v52, v8, v52
    v_mul_f32 v53, v9, v53
    v_cvt_pk_bf16_f32 v50, v52, v53
    v_mfma_f32_32x32x16_bf16 v[80:95], v[184:187], v[28:31], v[80:95]
    ds_read_b64_tr_b16 v[100:101], v13 offset:34816
    ds_read_b64_tr_b16 v[102:103], v13 offset:35328
    v_max_f32 v8, 0, v54
    v_max_f32 v9, 0, v55
    v_mul_f32 v54, v8, v54
    s_waitcnt lgkmcnt(4)
    v_mfma_f32_32x32x16_bf16 v[64:79], v[188:191], v[16:19], v[64:79]
    ds_read_b64_tr_b16 v[24:25], v12 offset:36864
    ds_read_b64_tr_b16 v[26:27], v12 offset:37376
    v_mul_f32 v55, v9, v55
    v_cvt_pk_bf16_f32 v51, v54, v55
    buffer_store_dwordx4 v[48:51], v116, s[8:11], s45 offen offset:0 sc1
    v_mfma_f32_32x32x16_bf16 v[80:95], v[188:191], v[20:23], v[80:95]
    ds_read_b64_tr_b16 v[28:29], v13 offset:36864
    ds_read_b64_tr_b16 v[30:31], v13 offset:37376
    v_max_f32 v8, 0, v56
    v_max_f32 v9, 0, v57
    v_mul_f32 v56, v8, v56
    s_waitcnt lgkmcnt(4)
    v_mfma_f32_32x32x16_bf16 v[64:79], v[192:195], v[96:99], v[64:79]
    ds_read_b64_tr_b16 v[16:17], v12 offset:38912
    ds_read_b64_tr_b16 v[18:19], v12 offset:39424
    v_mul_f32 v57, v9, v57
    v_cvt_pk_bf16_f32 v56, v56, v57
    v_max_f32 v8, 0, v58
    v_mfma_f32_32x32x16_bf16 v[80:95], v[192:195], v[100:103], v[80:95]
    ds_read_b64_tr_b16 v[20:21], v13 offset:38912
    ds_read_b64_tr_b16 v[22:23], v13 offset:39424
    v_max_f32 v9, 0, v59
    v_mul_f32 v58, v8, v58
    v_mul_f32 v59, v9, v59
    s_waitcnt lgkmcnt(4)
    v_mfma_f32_32x32x16_bf16 v[64:79], v[196:199], v[24:27], v[64:79]
    ds_read_b64_tr_b16 v[96:97], v12 offset:40960
    ds_read_b64_tr_b16 v[98:99], v12 offset:41472
    v_cvt_pk_bf16_f32 v57, v58, v59
    v_max_f32 v8, 0, v60
    v_max_f32 v9, 0, v61
    v_mfma_f32_32x32x16_bf16 v[80:95], v[196:199], v[28:31], v[80:95]
    ds_read_b64_tr_b16 v[100:101], v13 offset:40960
    ds_read_b64_tr_b16 v[102:103], v13 offset:41472
    v_mul_f32 v60, v8, v60
    v_mul_f32 v61, v9, v61
    v_cvt_pk_bf16_f32 v58, v60, v61
    s_waitcnt lgkmcnt(4)
    v_mfma_f32_32x32x16_bf16 v[64:79], v[200:203], v[16:19], v[64:79]
    ds_read_b64_tr_b16 v[24:25], v12 offset:43008
    ds_read_b64_tr_b16 v[26:27], v12 offset:43520
    v_max_f32 v8, 0, v62
    v_max_f32 v9, 0, v63
    v_mul_f32 v62, v8, v62
    v_mfma_f32_32x32x16_bf16 v[80:95], v[200:203], v[20:23], v[80:95]
    ds_read_b64_tr_b16 v[28:29], v13 offset:43008
    ds_read_b64_tr_b16 v[30:31], v13 offset:43520
    v_mul_f32 v63, v9, v63
    v_cvt_pk_bf16_f32 v59, v62, v63
    buffer_store_dwordx4 v[56:59], v116, s[8:11], s45 offen offset:1024 sc1
    s_waitcnt lgkmcnt(4)
    v_mfma_f32_32x32x16_bf16 v[64:79], v[204:207], v[96:99], v[64:79]
    ds_read_b64_tr_b16 v[16:17], v12 offset:45056
    ds_read_b64_tr_b16 v[18:19], v12 offset:45568
    s_lshr_b32 s57, s3, 1
    s_lshl_b32 s58, s31, 7
    s_lshl_b32 s59, s33, 5
    v_mfma_f32_32x32x16_bf16 v[80:95], v[204:207], v[100:103], v[80:95]
    ds_read_b64_tr_b16 v[20:21], v13 offset:45056
    ds_read_b64_tr_b16 v[22:23], v13 offset:45568
    s_add_u32 s58, s58, s59
    s_lshl_b32 s41, s57, 8
    v_xor_b32 v2, s41, v116
    s_waitcnt lgkmcnt(4)
    v_mfma_f32_32x32x16_bf16 v[64:79], v[208:211], v[24:27], v[64:79]
    ds_read_b64_tr_b16 v[96:97], v12 offset:47104
    ds_read_b64_tr_b16 v[98:99], v12 offset:47616
    s_lshr_b32 s40, s58, 5
    s_mul_i32 s40, s40, 114688
    s_mul_i32 s62, s3, 28672
    v_mfma_f32_32x32x16_bf16 v[80:95], v[208:211], v[28:31], v[80:95]
    ds_read_b64_tr_b16 v[100:101], v13 offset:47104
    ds_read_b64_tr_b16 v[102:103], v13 offset:47616
    s_add_u32 s40, s40, s62
    s_add_u32 s40, s40, s37
    v_and_b32 v4, 31, v0
    s_waitcnt vmcnt(4)
    s_barrier
    s_waitcnt lgkmcnt(4)
    v_mfma_f32_32x32x16_bf16 v[64:79], v[212:215], v[16:19], v[64:79]
    ds_read_b64_tr_b16 v[24:25], v12 offset:49152
    ds_read_b64_tr_b16 v[26:27], v12 offset:49664
    v_bfe_u32 v5, v0, 5, 1
    s_and_b32 s59, s3, 1
    s_lshl_b32 s43, s34, 1
    v_mfma_f32_32x32x16_bf16 v[80:95], v[212:215], v[20:23], v[80:95]
    ds_read_b64_tr_b16 v[28:29], v13 offset:49152
    ds_read_b64_tr_b16 v[30:31], v13 offset:49664
    s_add_u32 s43, s43, s59
    s_lshl_b32 s63, s57, 4
    s_add_u32 s63, s63, s58
    buffer_load_dword v114, v15, s[8:11], s48 offen offset:256 sc1
    buffer_load_dword v115, v15, s[8:11], s48 offen offset:384 sc1
    s_waitcnt lgkmcnt(4)
    v_mfma_f32_32x32x16_bf16 v[64:79], v[216:219], v[96:99], v[64:79]
    ds_read_b64_tr_b16 v[16:17], v12 offset:51200
    ds_read_b64_tr_b16 v[18:19], v12 offset:51712
    v_lshlrev_b32 v6, 12, v4
    v_lshl_add_u32 v6, v5, 3, v6
    s_lshl_b32 s42, s43, 17
    v_mfma_f32_32x32x16_bf16 v[80:95], v[216:219], v[100:103], v[80:95]
    ds_read_b64_tr_b16 v[20:21], v13 offset:51200
    ds_read_b64_tr_b16 v[22:23], v13 offset:51712
    s_lshl_b32 s62, s63, 1
    s_add_u32 s42, s42, s62
    s_add_u32 s42, s42, s36
    s_waitcnt lgkmcnt(4)
    v_mfma_f32_32x32x16_bf16 v[64:79], v[220:223], v[24:27], v[64:79]
    ds_read_b64_tr_b16 v[96:97], v12 offset:53248
    ds_read_b64_tr_b16 v[98:99], v12 offset:53760
    s_lshl_b32 s60, s31, 10
    s_add_u32 s60, s60, 0x180e000
    s_lshl_b32 s61, s29, 1
    v_mfma_f32_32x32x16_bf16 v[80:95], v[220:223], v[28:31], v[80:95]
    ds_read_b64_tr_b16 v[100:101], v13 offset:53248
    ds_read_b64_tr_b16 v[102:103], v13 offset:53760
    s_add_u32 s61, s61, 1
    v_lshlrev_b32 v117, 2, v116
    s_lshl_b32 s49, s63, 2
    s_waitcnt lgkmcnt(4)
    v_mfma_f32_32x32x16_bf16 v[64:79], v[224:227], v[16:19], v[64:79]
    ds_read_b64_tr_b16 v[24:25], v12 offset:55296
    ds_read_b64_tr_b16 v[26:27], v12 offset:55808
    s_add_u32 s49, s49, s38
    s_lshl_b32 s13, s43, 6
    v_lshrrev_b32 v7, 2, v0
    v_mfma_f32_32x32x16_bf16 v[80:95], v[224:227], v[20:23], v[80:95]
    ds_read_b64_tr_b16 v[28:29], v13 offset:55296
    ds_read_b64_tr_b16 v[30:31], v13 offset:55808
    v_mul_u32_u24 v7, 144, v7
    v_and_b32 v5, 3, v0
    v_lshl_add_u32 v7, v5, 4, v7
    s_waitcnt lgkmcnt(4)
    v_mfma_f32_32x32x16_bf16 v[64:79], v[228:231], v[96:99], v[64:79]
    ds_read_b64_tr_b16 v[16:17], v12 offset:57344
    ds_read_b64_tr_b16 v[18:19], v12 offset:57856
    v_add_u32 v7, 135168, v7
    s_xor_b32 s52, s3, 1
    s_mul_i32 s52, s52, 6144
    v_mfma_f32_32x32x16_bf16 v[80:95], v[228:231], v[100:103], v[80:95]
    ds_read_b64_tr_b16 v[20:21], v13 offset:57344
    ds_read_b64_tr_b16 v[22:23], v13 offset:57856
    s_add_u32 s52, s52, 0
    v_add_u32 v10, s52, v116
    s_xor_b32 s52, s3, 2
    s_waitcnt lgkmcnt(4)
    v_mfma_f32_32x32x16_bf16 v[64:79], v[232:235], v[24:27], v[64:79]
    ds_read_b64_tr_b16 v[96:97], v12 offset:59392
    ds_read_b64_tr_b16 v[98:99], v12 offset:59904
    s_mul_i32 s52, s52, 6144
    s_add_u32 s52, s52, 2048
    v_add_u32 v4, s52, v116
    v_mfma_f32_32x32x16_bf16 v[80:95], v[232:235], v[28:31], v[80:95]
    ds_read_b64_tr_b16 v[100:101], v13 offset:59392
    ds_read_b64_tr_b16 v[102:103], v13 offset:59904
    s_xor_b32 s52, s3, 3
    s_mul_i32 s52, s52, 6144
    s_add_u32 s52, s52, 4096
    s_waitcnt lgkmcnt(4)
    v_mfma_f32_32x32x16_bf16 v[64:79], v[236:239], v[16:19], v[64:79]
    ds_read_b64_tr_b16 v[24:25], v12 offset:61440
    ds_read_b64_tr_b16 v[26:27], v12 offset:61952
    v_add_u32 v5, s52, v116
    s_mul_i32 s52, s3, 6144
    v_add_u32 v11, s52, v116
    v_mfma_f32_32x32x16_bf16 v[80:95], v[236:239], v[20:23], v[80:95]
    ds_read_b64_tr_b16 v[28:29], v13 offset:61440
    ds_read_b64_tr_b16 v[30:31], v13 offset:61952
    s_lshl_b32 s54, s58, 10
    s_lshl_b32 s52, s34, 12
    s_add_u32 s54, s54, s52
    s_waitcnt lgkmcnt(4)
    v_mfma_f32_32x32x16_bf16 v[64:79], v[240:243], v[96:99], v[64:79]
    ds_read_b64_tr_b16 v[16:17], v12 offset:63488
    ds_read_b64_tr_b16 v[18:19], v12 offset:64000
    s_lshl_b32 s52, s3, 10
    s_add_u32 s54, s54, s52
    s_add_u32 s54, s54, 0x400000
    v_mfma_f32_32x32x16_bf16 v[80:95], v[240:243], v[100:103], v[80:95]
    ds_read_b64_tr_b16 v[20:21], v13 offset:63488
    ds_read_b64_tr_b16 v[22:23], v13 offset:64000
    s_lshl_b32 s56, s34, 7
    s_mov_b32 s59, 0x3f803f80
    s_waitcnt vmcnt(2)
    s_barrier
    s_lshl_b32 s55, s29, 1
    s_add_u32 s55, s55, 1
    v_mov_b32 v118, s55
    v_mov_b32 v119, 0
    s_cmp_eq_u32 s3, 0
    s_cselect_b64 exec, 1, 0
    buffer_store_dword v118, v119, s[8:11], s51 offen sc1
    s_mov_b64 exec, -1
    s_waitcnt lgkmcnt(4)
    v_mfma_f32_32x32x16_bf16 v[64:79], v[244:247], v[24:27], v[64:79]
    v_mfma_f32_32x32x16_bf16 v[80:95], v[244:247], v[28:31], v[80:95]
    s_waitcnt lgkmcnt(0)
    v_mfma_f32_32x32x16_bf16 v[64:79], v[248:251], v[16:19], v[64:79]
    v_mfma_f32_32x32x16_bf16 v[80:95], v[248:251], v[20:23], v[80:95]
    s_waitcnt vmcnt(1)
    v_min_u32 v8, v114, v115
    v_cmp_eq_u32 s[52:53], 0, v8
    s_nop 0
    s_cmp_lg_u64 s[52:53], 0
    s_cbranch_scc1 L_lp_4
L_lk_5:
    v_cndmask_b32 v105, 0, v114, s[14:15]
    v_mov_b32 v106, 0
    v_mov_b32 v107, 0
    v_perm_b32 v104, v105, v105, s12
    v_cndmask_b32 v109, 0, v115, s[14:15]
    v_mov_b32 v110, 0
    v_mov_b32 v111, 0
    v_perm_b32 v108, v109, v109, s12
    s_nop 1
    v_mfma_f32_32x32x16_bf16 v[64:79], v[252:255], v[104:107], v[64:79]
    v_mfma_f32_32x32x16_bf16 v[80:95], v[252:255], v[108:111], v[80:95]
    v_and_b32 v12, 31, v0
    s_and_b32 s52, s3, 1
    s_lshl_b32 s52, s52, 5
    v_add_u32 v12, s52, v12
    v_mul_u32_u24 v12, 144, v12
    v_bfe_u32 v13, v0, 5, 1
    v_lshl_add_u32 v12, v13, 4, v12
    s_lshl_b32 s52, s57, 5
    s_add_u32 s52, s52, 135168
    v_add_u32 v12, s52, v12
    v_bfe_u32 v15, v0, 4, 2
    v_bfe_u32 v13, v0, 2, 2
    v_lshl_add_u32 v13, v15, 4, v13
    v_mul_u32_u24 v13, 144, v13
    v_and_b32 v14, 3, v0
    v_lshl_add_u32 v13, v14, 3, v13
    s_and_b32 s52, s3, 1
    s_lshl_b32 s53, s52, 5
    s_add_u32 s53, s53, 135168
    v_add_u32 v13, s53, v13
    s_lshl_b32 s52, s52, 4
    s_add_u32 s52, s52, s58
    v_and_b32 v14, 15, v0
    v_add_u32 v14, s52, v14
    v_bfe_u32 v8, v0, 5, 1
    v_lshlrev_b32 v8, 4, v8
    v_and_b32 v9, 31, v0
    v_lshlrev_b32 v9, 1, v9
    buffer_load_ushort v3, v9, s[20:23], s13 offen
    v_bfe_u32 v6, v0, 1, 1
    v_xor_b32 v6, s33, v6
    v_lshlrev_b32 v6, 6, v6
    v_and_b32 v9, 31, v0
    v_lshl_add_u32 v6, v9, 7, v6
    v_bfe_u32 v9, v0, 5, 1
    v_lshl_add_u32 v6, v9, 3, v6
    s_lshl_b32 s52, s43, 12
    s_lshl_b32 s53, s57, 5
    s_add_u32 s52, s52, s53
    v_add_u32 v6, s52, v6
    v_add_u32 v9, 0x10000, v6
    ds_read_b64 v[96:97], v6 offset:0
    ds_read_b64 v[98:99], v6 offset:16
    ds_read_b64 v[100:101], v9 offset:0
    ds_read_b64 v[102:103], v9 offset:16
    v_max_f32 v64, 0, v64
    v_max_f32 v65, 0, v65
    v_max_f32 v66, 0, v66
    v_max_f32 v67, 0, v67
    v_max_f32 v68, 0, v68
    v_max_f32 v69, 0, v69
    v_max_f32 v70, 0, v70
    v_max_f32 v71, 0, v71
    v_pk_mul_f32 v[64:65], v[64:65], v[64:65]
    v_pk_mul_f32 v[66:67], v[66:67], v[66:67]
    v_pk_mul_f32 v[68:69], v[68:69], v[68:69]
    v_pk_mul_f32 v[70:71], v[70:71], v[70:71]
    v_cvt_pk_bf16_f32 v64, v64, v65
    v_cvt_pk_bf16_f32 v65, v66, v67
    v_cvt_pk_bf16_f32 v66, v68, v69
    v_cvt_pk_bf16_f32 v67, v70, v71
    buffer_store_dwordx4 v[64:67], v116, s[8:11], s46 offen offset:0 sc1
    v_max_f32 v72, 0, v72
    v_max_f32 v73, 0, v73
    v_max_f32 v74, 0, v74
    v_max_f32 v75, 0, v75
    v_max_f32 v76, 0, v76
    v_max_f32 v77, 0, v77
    v_max_f32 v78, 0, v78
    v_max_f32 v79, 0, v79
    v_pk_mul_f32 v[72:73], v[72:73], v[72:73]
    v_pk_mul_f32 v[74:75], v[74:75], v[74:75]
    v_pk_mul_f32 v[76:77], v[76:77], v[76:77]
    v_pk_mul_f32 v[78:79], v[78:79], v[78:79]
    v_cvt_pk_bf16_f32 v72, v72, v73
    v_cvt_pk_bf16_f32 v73, v74, v75
    v_cvt_pk_bf16_f32 v74, v76, v77
    v_cvt_pk_bf16_f32 v75, v78, v79
    buffer_store_dwordx4 v[72:75], v116, s[8:11], s46 offen offset:1024 sc1
    v_max_f32 v80, 0, v80
    v_max_f32 v81, 0, v81
    v_max_f32 v82, 0, v82
    v_max_f32 v83, 0, v83
    v_max_f32 v84, 0, v84
    v_max_f32 v85, 0, v85
    v_max_f32 v86, 0, v86
    v_max_f32 v87, 0, v87
    v_pk_mul_f32 v[80:81], v[80:81], v[80:81]
    v_pk_mul_f32 v[82:83], v[82:83], v[82:83]
    v_pk_mul_f32 v[84:85], v[84:85], v[84:85]
    v_pk_mul_f32 v[86:87], v[86:87], v[86:87]
    v_cvt_pk_bf16_f32 v80, v80, v81
    v_cvt_pk_bf16_f32 v81, v82, v83
    v_cvt_pk_bf16_f32 v82, v84, v85
    v_cvt_pk_bf16_f32 v83, v86, v87
    buffer_store_dwordx4 v[80:83], v116, s[8:11], s47 offen offset:0 sc1
    v_max_f32 v88, 0, v88
    v_max_f32 v89, 0, v89
    v_max_f32 v90, 0, v90
    v_max_f32 v91, 0, v91
    v_max_f32 v92, 0, v92
    v_max_f32 v93, 0, v93
    v_max_f32 v94, 0, v94
    v_max_f32 v95, 0, v95
    v_pk_mul_f32 v[88:89], v[88:89], v[88:89]
    v_pk_mul_f32 v[90:91], v[90:91], v[90:91]
    v_pk_mul_f32 v[92:93], v[92:93], v[92:93]
    v_pk_mul_f32 v[94:95], v[94:95], v[94:95]
    v_cvt_pk_bf16_f32 v88, v88, v89
    v_cvt_pk_bf16_f32 v89, v90, v91
    v_cvt_pk_bf16_f32 v90, v92, v93
    v_cvt_pk_bf16_f32 v91, v94, v95
    buffer_store_dwordx4 v[88:91], v116, s[8:11], s47 offen offset:1024 sc1
    s_mov_b64 exec, 0x3fff
L_sp_6:
    s_sub_u32 s30, s30, 1
    s_cbranch_scc0 L_sp_6c
    s_mov_b32 s30, 0
    s_branch L_sp_6x
L_sp_6c:
    buffer_load_dword v119, v117, s[8:11], s60 offen sc1
    s_waitcnt vmcnt(0)
    v_cmpx_gt_u32 s[52:53], s61, v119
    s_cbranch_execnz L_sp_6
L_sp_6x:
    s_mov_b64 exec, -1
    s_waitcnt lgkmcnt(0)
    s_barrier
    buffer_load_dwordx4 v[16:19], v2, s[8:11], s40 offen offset:0 sc1
    buffer_load_dwordx4 v[20:23], v2, s[8:11], s40 offen offset:1024 sc1
    buffer_load_dwordx4 v[24:27], v2, s[8:11], s40 offen offset:2048 sc1
    s_lshl_b32 s55, s29, 1
    s_add_u32 s55, s55, 2
    v_mov_b32 v118, s55
    v_mov_b32 v119, 0
    s_cmp_eq_u32 s3, 0
    s_cselect_b64 exec, 1, 0
    buffer_store_dword v118, v119, s[8:11], s51 offen sc1
    s_mov_b64 exec, -1
    s_branch L_g2
L_stats:
    v_bfe_u32 v4, v0, 3, 3
    v_lshrrev_b32 v5, 1, v4
    v_lshlrev_b32 v5, 1, v5
    v_and_b32 v6, 7, v0
    v_xor_b32 v5, v5, v6
    v_lshlrev_b32 v5, 4, v5
    v_lshl_add_u32 v3, v4, 12, v5
    s_and_b32 s43, s2, 15
    s_lshl_b32 s43, s43, 1
    s_bfe_u32 s44, s2, 0x10004
    s_add_u32 s43, s43, s44
    s_lshl_b32 s40, s43, 7
    s_add_u32 s40, s40, s36
    s_lshl_b32 s41, s3, 15
    s_lshl_b32 m0, s3, 10
    s_add_u32 s40, s40, s41
    buffer_load_dwordx4 v3, s[8:11], s40 offen sc1 lds
    s_add_u32 m0, m0, 4096
    s_add_u32 s40, s40, 131072
    buffer_load_dwordx4 v3, s[8:11], s40 offen sc1 lds
    s_add_u32 m0, m0, 4096
    s_add_u32 s40, s40, 131072
    buffer_load_dwordx4 v3, s[8:11], s40 offen sc1 lds
    s_add_u32 m0, m0, 4096
    s_add_u32 s40, s40, 131072
    buffer_load_dwordx4 v3, s[8:11], s40 offen sc1 lds
    s_add_u32 m0, m0, 4096
    s_add_u32 s40, s40, 131072
    buffer_load_dwordx4 v3, s[8:11], s40 offen sc1 lds
    s_add_u32 m0, m0, 4096
    s_add_u32 s40, s40, 131072
    buffer_load_dwordx4 v3, s[8:11], s40 offen sc1 lds
    s_add_u32 m0, m0, 4096
    s_add_u32 s40, s40, 131072
    buffer_load_dwordx4 v3, s[8:11], s40 offen sc1 lds
    s_add_u32 m0, m0, 4096
    s_add_u32 s40, s40, 131072
    buffer_load_dwordx4 v3, s[8:11], s40 offen sc1 lds
    s_add_u32 m0, m0, 4096
    s_add_u32 s40, s40, 131072
    buffer_load_dwordx4 v3, s[8:11], s40 offen sc1 lds
    s_add_u32 m0, m0, 4096
    s_add_u32 s40, s40, 131072
    buffer_load_dwordx4 v3, s[8:11], s40 offen sc1 lds
    s_add_u32 m0, m0, 4096
    s_add_u32 s40, s40, 131072
    buffer_load_dwordx4 v3, s[8:11], s40 offen sc1 lds
    s_add_u32 m0, m0, 4096
    s_add_u32 s40, s40, 131072
    buffer_load_dwordx4 v3, s[8:11], s40 offen sc1 lds
    s_add_u32 m0, m0, 4096
    s_add_u32 s40, s40, 131072
    buffer_load_dwordx4 v3, s[8:11], s40 offen sc1 lds
    s_add_u32 m0, m0, 4096
    s_add_u32 s40, s40, 131072
    buffer_load_dwordx4 v3, s[8:11], s40 offen sc1 lds
    s_add_u32 m0, m0, 4096
    s_add_u32 s40, s40, 131072
    buffer_load_dwordx4 v3, s[8:11], s40 offen sc1 lds
    s_add_u32 m0, m0, 4096
    s_add_u32 s40, s40, 131072
    buffer_load_dwordx4 v3, s[8:11], s40 offen sc1 lds
    v_bfe_u32 v5, v0, 2, 2
    v_bfe_u32 v6, v0, 4, 1
    v_bfe_u32 v7, v0, 5, 1
    v_lshl_add_u32 v4, v6, 2, v5
    v_lshrrev_b32 v8, 1, v4
    v_lshl_add_u32 v4, v7, 4, v4
    v_lshlrev_b32 v4, 7, v4
    v_xor_b32 v8, s3, v8
    v_lshl_add_u32 v4, v8, 5, v4
    v_and_b32 v8, 3, v0
    v_lshl_add_u32 v4, v8, 3, v4
    s_mov_b32 s42, 0x3f803f80
    v_mov_b32 v10, 0
    v_mov_b32 v11, 0
    v_mov_b32 v12, 0
    v_mov_b32 v13, 0
    s_waitcnt vmcnt(12)
    s_barrier
    ds_read_b64_tr_b16 v[16:17], v4 offset:0
    ds_read_b64_tr_b16 v[18:19], v4 offset:1024
    ds_read_b64_tr_b16 v[20:21], v4 offset:4096
    ds_read_b64_tr_b16 v[22:23], v4 offset:5120
    ds_read_b64_tr_b16 v[24:25], v4 offset:8192
    ds_read_b64_tr_b16 v[26:27], v4 offset:9216
    ds_read_b64_tr_b16 v[28:29], v4 offset:12288
    ds_read_b64_tr_b16 v[30:31], v4 offset:13312
    s_waitcnt lgkmcnt(6)
    v_dot2_f32_bf16 v10, v16, s42, v10
    v_dot2_f32_bf16 v12, v16, v16, v12
    v_dot2_f32_bf16 v11, v17, s42, v11
    v_dot2_f32_bf16 v13, v17, v17, v13
    v_dot2_f32_bf16 v10, v18, s42, v10
    v_dot2_f32_bf16 v12, v18, v18, v12
    v_dot2_f32_bf16 v11, v19, s42, v11
    v_dot2_f32_bf16 v13, v19, v19, v13
    s_waitcnt lgkmcnt(4)
    v_dot2_f32_bf16 v10, v20, s42, v10
    v_dot2_f32_bf16 v12, v20, v20, v12
    v_dot2_f32_bf16 v11, v21, s42, v11
    v_dot2_f32_bf16 v13, v21, v21, v13
    v_dot2_f32_bf16 v10, v22, s42, v10
    v_dot2_f32_bf16 v12, v22, v22, v12
    v_dot2_f32_bf16 v11, v23, s42, v11
    v_dot2_f32_bf16 v13, v23, v23, v13
    s_waitcnt lgkmcnt(2)
    v_dot2_f32_bf16 v10, v24, s42, v10
    v_dot2_f32_bf16 v12, v24, v24, v12
    v_dot2_f32_bf16 v11, v25, s42, v11
    v_dot2_f32_bf16 v13, v25, v25, v13
    v_dot2_f32_bf16 v10, v26, s42, v10
    v_dot2_f32_bf16 v12, v26, v26, v12
    v_dot2_f32_bf16 v11, v27, s42, v11
    v_dot2_f32_bf16 v13, v27, v27, v13
    s_waitcnt lgkmcnt(0)
    v_dot2_f32_bf16 v10, v28, s42, v10
    v_dot2_f32_bf16 v12, v28, v28, v12
    v_dot2_f32_bf16 v11, v29, s42, v11
    v_dot2_f32_bf16 v13, v29, v29, v13
    v_dot2_f32_bf16 v10, v30, s42, v10
    v_dot2_f32_bf16 v12, v30, v30, v12
    v_dot2_f32_bf16 v11, v31, s42, v11
    v_dot2_f32_bf16 v13, v31, v31, v13
    s_waitcnt vmcnt(8)
    s_barrier
    ds_read_b64_tr_b16 v[16:17], v4 offset:16384
    ds_read_b64_tr_b16 v[18:19], v4 offset:17408
    ds_read_b64_tr_b16 v[20:21], v4 offset:20480
    ds_read_b64_tr_b16 v[22:23], v4 offset:21504
    ds_read_b64_tr_b16 v[24:25], v4 offset:24576
    ds_read_b64_tr_b16 v[26:27], v4 offset:25600
    ds_read_b64_tr_b16 v[28:29], v4 offset:28672
    ds_read_b64_tr_b16 v[30:31], v4 offset:29696
    s_waitcnt lgkmcnt(6)
    v_dot2_f32_bf16 v10, v16, s42, v10
    v_dot2_f32_bf16 v12, v16, v16, v12
    v_dot2_f32_bf16 v11, v17, s42, v11
    v_dot2_f32_bf16 v13, v17, v17, v13
    v_dot2_f32_bf16 v10, v18, s42, v10
    v_dot2_f32_bf16 v12, v18, v18, v12
    v_dot2_f32_bf16 v11, v19, s42, v11
    v_dot2_f32_bf16 v13, v19, v19, v13
    s_waitcnt lgkmcnt(4)
    v_dot2_f32_bf16 v10, v20, s42, v10
    v_dot2_f32_bf16 v12, v20, v20, v12
    v_dot2_f32_bf16 v11, v21, s42, v11
    v_dot2_f32_bf16 v13, v21, v21, v13
    v_dot2_f32_bf16 v10, v22, s42, v10
    v_dot2_f32_bf16 v12, v22, v22, v12
    v_dot2_f32_bf16 v11, v23, s42, v11
    v_dot2_f32_bf16 v13, v23, v23, v13
    s_waitcnt lgkmcnt(2)
    v_dot2_f32_bf16 v10, v24, s42, v10
    v_dot2_f32_bf16 v12, v24, v24, v12
    v_dot2_f32_bf16 v11, v25, s42, v11
    v_dot2_f32_bf16 v13, v25, v25, v13
    v_dot2_f32_bf16 v10, v26, s42, v10
    v_dot2_f32_bf16 v12, v26, v26, v12
    v_dot2_f32_bf16 v11, v27, s42, v11
    v_dot2_f32_bf16 v13, v27, v27, v13
    s_waitcnt lgkmcnt(0)
    v_dot2_f32_bf16 v10, v28, s42, v10
    v_dot2_f32_bf16 v12, v28, v28, v12
    v_dot2_f32_bf16 v11, v29, s42, v11
    v_dot2_f32_bf16 v13, v29, v29, v13
    v_dot2_f32_bf16 v10, v30, s42, v10
    v_dot2_f32_bf16 v12, v30, v30, v12
    v_dot2_f32_bf16 v11, v31, s42, v11
    v_dot2_f32_bf16 v13, v31, v31, v13
    s_waitcnt vmcnt(4)
    s_barrier
    ds_read_b64_tr_b16 v[16:17], v4 offset:32768
    ds_read_b64_tr_b16 v[18:19], v4 offset:33792
    ds_read_b64_tr_b16 v[20:21], v4 offset:36864
    ds_read_b64_tr_b16 v[22:23], v4 offset:37888
    ds_read_b64_tr_b16 v[24:25], v4 offset:40960
    ds_read_b64_tr_b16 v[26:27], v4 offset:41984
    ds_read_b64_tr_b16 v[28:29], v4 offset:45056
    ds_read_b64_tr_b16 v[30:31], v4 offset:46080
    s_waitcnt lgkmcnt(6)
    v_dot2_f32_bf16 v10, v16, s42, v10
    v_dot2_f32_bf16 v12, v16, v16, v12
    v_dot2_f32_bf16 v11, v17, s42, v11
    v_dot2_f32_bf16 v13, v17, v17, v13
    v_dot2_f32_bf16 v10, v18, s42, v10
    v_dot2_f32_bf16 v12, v18, v18, v12
    v_dot2_f32_bf16 v11, v19, s42, v11
    v_dot2_f32_bf16 v13, v19, v19, v13
    s_waitcnt lgkmcnt(4)
    v_dot2_f32_bf16 v10, v20, s42, v10
    v_dot2_f32_bf16 v12, v20, v20, v12
    v_dot2_f32_bf16 v11, v21, s42, v11
    v_dot2_f32_bf16 v13, v21, v21, v13
    v_dot2_f32_bf16 v10, v22, s42, v10
    v_dot2_f32_bf16 v12, v22, v22, v12
    v_dot2_f32_bf16 v11, v23, s42, v11
    v_dot2_f32_bf16 v13, v23, v23, v13
    s_waitcnt lgkmcnt(2)
    v_dot2_f32_bf16 v10, v24, s42, v10
    v_dot2_f32_bf16 v12, v24, v24, v12
    v_dot2_f32_bf16 v11, v25, s42, v11
    v_dot2_f32_bf16 v13, v25, v25, v13
    v_dot2_f32_bf16 v10, v26, s42, v10
    v_dot2_f32_bf16 v12, v26, v26, v12
    v_dot2_f32_bf16 v11, v27, s42, v11
    v_dot2_f32_bf16 v13, v27, v27, v13
    s_waitcnt lgkmcnt(0)
    v_dot2_f32_bf16 v10, v28, s42, v10
    v_dot2_f32_bf16 v12, v28, v28, v12
    v_dot2_f32_bf16 v11, v29, s42, v11
    v_dot2_f32_bf16 v13, v29, v29, v13
    v_dot2_f32_bf16 v10, v30, s42, v10
    v_dot2_f32_bf16 v12, v30, v30, v12
    v_dot2_f32_bf16 v11, v31, s42, v11
    v_dot2_f32_bf16 v13, v31, v31, v13
    s_waitcnt vmcnt(0)
    s_barrier
    ds_read_b64_tr_b16 v[16:17], v4 offset:49152
    ds_read_b64_tr_b16 v[18:19], v4 offset:50176
    ds_read_b64_tr_b16 v[20:21], v4 offset:53248
    ds_read_b64_tr_b16 v[22:23], v4 offset:54272
    ds_read_b64_tr_b16 v[24:25], v4 offset:57344
    ds_read_b64_tr_b16 v[26:27], v4 offset:58368
    ds_read_b64_tr_b16 v[28:29], v4 offset:61440
    ds_read_b64_tr_b16 v[30:31], v4 offset:62464
    s_waitcnt lgkmcnt(6)
    v_dot2_f32_bf16 v10, v16, s42, v10
    v_dot2_f32_bf16 v12, v16, v16, v12
    v_dot2_f32_bf16 v11, v17, s42, v11
    v_dot2_f32_bf16 v13, v17, v17, v13
    v_dot2_f32_bf16 v10, v18, s42, v10
    v_dot2_f32_bf16 v12, v18, v18, v12
    v_dot2_f32_bf16 v11, v19, s42, v11
    v_dot2_f32_bf16 v13, v19, v19, v13
    s_waitcnt lgkmcnt(4)
    v_dot2_f32_bf16 v10, v20, s42, v10
    v_dot2_f32_bf16 v12, v20, v20, v12
    v_dot2_f32_bf16 v11, v21, s42, v11
    v_dot2_f32_bf16 v13, v21, v21, v13
    v_dot2_f32_bf16 v10, v22, s42, v10
    v_dot2_f32_bf16 v12, v22, v22, v12
    v_dot2_f32_bf16 v11, v23, s42, v11
    v_dot2_f32_bf16 v13, v23, v23, v13
    s_waitcnt lgkmcnt(2)
    v_dot2_f32_bf16 v10, v24, s42, v10
    v_dot2_f32_bf16 v12, v24, v24, v12
    v_dot2_f32_bf16 v11, v25, s42, v11
    v_dot2_f32_bf16 v13, v25, v25, v13
    v_dot2_f32_bf16 v10, v26, s42, v10
    v_dot2_f32_bf16 v12, v26, v26, v12
    v_dot2_f32_bf16 v11, v27, s42, v11
    v_dot2_f32_bf16 v13, v27, v27, v13
    s_waitcnt lgkmcnt(0)
    v_dot2_f32_bf16 v10, v28, s42, v10
    v_dot2_f32_bf16 v12, v28, v28, v12
    v_dot2_f32_bf16 v11, v29, s42, v11
    v_dot2_f32_bf16 v13, v29, v29, v13
    v_dot2_f32_bf16 v10, v30, s42, v10
    v_dot2_f32_bf16 v12, v30, v30, v12
    v_dot2_f32_bf16 v11, v31, s42, v11
    v_dot2_f32_bf16 v13, v31, v31, v13
    s_nop 2
    v_add_f32 v10, v10, v11
    v_add_f32 v12, v12, v13
    v_mov_b32 v11, v10
    v_mov_b32 v13, v12
    s_nop 1
    v_permlane32_swap_b32 v10, v11
    v_permlane32_swap_b32 v12, v13
    s_nop 1
    v_add_f32 v10, v10, v11
    v_add_f32 v12, v12, v13
    v_mov_b32 v11, v10
    v_mov_b32 v13, v12
    s_nop 1
    v_permlane16_swap_b32 v10, v11
    v_permlane16_swap_b32 v12, v13
    s_nop 1
    v_add_f32 v10, v10, v11
    v_add_f32 v12, v12, v13
    v_mul_f32 v10, 0x3b000000, v10
    v_mul_f32 v12, 0x3b000000, v12
    v_fma_f32 v12, -v10, v10, v12
    v_max_f32 v12, 0, v12
    v_cvt_pk_bf16_f32 v10, v10, v12
    v_and_b32 v12, 0xffff0000, v10
    v_lshlrev_b32 v10, 16, v10
    v_add_f32 v12, 0x3727c5ac, v12
    v_cvt_pk_bf16_f32 v12, v12, v12
    v_lshlrev_b32 v12, 16, v12
    v_sqrt_f32 v12, v12
    s_nop 0
    v_cvt_pk_bf16_f32 v12, v12, v12
    v_lshlrev_b32 v12, 16, v12
    v_sub_f32 v10, 0, v10
    v_cvt_pk_bf16_f32 v10, v10, v12
    v_and_b32 v11, 15, v0
    v_lshlrev_b32 v11, 2, v11
    s_lshl_b32 s40, s43, 8
    s_lshl_b32 s41, s3, 6
    s_add_u32 s40, s40, s41
    s_add_u32 s40, s40, s38
    s_mov_b64 exec, 0xffff
    buffer_store_dword v10, v11, s[8:11], s40 offen sc1
    s_mov_b64 exec, -1
    s_barrier
    s_lshr_b32 s57, s3, 1
    s_lshl_b32 s58, s31, 7
    s_lshl_b32 s59, s33, 5
    s_add_u32 s58, s58, s59
    s_lshl_b32 s41, s57, 8
    v_xor_b32 v2, s41, v116
    s_lshr_b32 s40, s58, 5
    s_mul_i32 s40, s40, 114688
    s_mul_i32 s62, s3, 28672
    s_add_u32 s40, s40, s62
    s_add_u32 s40, s40, s37
    v_and_b32 v4, 31, v0
    v_bfe_u32 v5, v0, 5, 1
    s_and_b32 s59, s3, 1
    s_lshl_b32 s43, s34, 1
    s_add_u32 s43, s43, s59
    s_lshl_b32 s63, s57, 4
    s_add_u32 s63, s63, s58
    v_lshlrev_b32 v6, 12, v4
    v_lshl_add_u32 v6, v5, 3, v6
    s_lshl_b32 s42, s43, 17
    s_lshl_b32 s62, s63, 1
    s_add_u32 s42, s42, s62
    s_add_u32 s42, s42, s36
    s_lshl_b32 s60, s31, 10
    s_add_u32 s60, s60, 0x180e000
    s_lshl_b32 s61, s29, 1
    s_add_u32 s61, s61, 1
    v_lshlrev_b32 v117, 2, v116
    s_lshl_b32 s49, s63, 2
    s_add_u32 s49, s49, s38
    s_lshl_b32 s13, s43, 6
    v_lshrrev_b32 v7, 2, v0
    v_mul_u32_u24 v7, 144, v7
    v_and_b32 v5, 3, v0
    v_lshl_add_u32 v7, v5, 4, v7
    v_add_u32 v7, 135168, v7
    s_xor_b32 s52, s3, 1
    s_mul_i32 s52, s52, 6144
    s_add_u32 s52, s52, 0
    v_add_u32 v10, s52, v116
    s_xor_b32 s52, s3, 2
    s_mul_i32 s52, s52, 6144
    s_add_u32 s52, s52, 2048
    v_add_u32 v4, s52, v116
    s_xor_b32 s52, s3, 3
    s_mul_i32 s52, s52, 6144
    s_add_u32 s52, s52, 4096
    v_add_u32 v5, s52, v116
    s_mul_i32 s52, s3, 6144
    v_add_u32 v11, s52, v116
    s_lshl_b32 s54, s58, 10
    s_lshl_b32 s52, s34, 12
    s_add_u32 s54, s54, s52
    s_lshl_b32 s52, s3, 10
    s_add_u32 s54, s54, s52
    s_add_u32 s54, s54, 0x400000
    s_lshl_b32 s56, s34, 7
    s_mov_b32 s59, 0x3f803f80
    v_and_b32 v12, 31, v0
    s_and_b32 s52, s3, 1
    s_lshl_b32 s52, s52, 5
    v_add_u32 v12, s52, v12
    v_mul_u32_u24 v12, 144, v12
    v_bfe_u32 v13, v0, 5, 1
    v_lshl_add_u32 v12, v13, 4, v12
    s_lshl_b32 s52, s57, 5
    s_add_u32 s52, s52, 135168
    v_add_u32 v12, s52, v12
    v_bfe_u32 v15, v0, 4, 2
    v_bfe_u32 v13, v0, 2, 2
    v_lshl_add_u32 v13, v15, 4, v13
    v_mul_u32_u24 v13, 144, v13
    v_and_b32 v14, 3, v0
    v_lshl_add_u32 v13, v14, 3, v13
    s_and_b32 s52, s3, 1
    s_lshl_b32 s53, s52, 5
    s_add_u32 s53, s53, 135168
    v_add_u32 v13, s53, v13
    s_lshl_b32 s52, s52, 4
    s_add_u32 s52, s52, s58
    v_and_b32 v14, 15, v0
    v_add_u32 v14, s52, v14
    v_bfe_u32 v8, v0, 5, 1
    v_lshlrev_b32 v8, 4, v8
    v_and_b32 v9, 31, v0
    v_lshlrev_b32 v9, 1, v9
    buffer_load_ushort v3, v9, s[20:23], s13 offen
    buffer_load_dwordx2 v[96:97], v6, s[8:11], s42 offen offset:0 sc1
    buffer_load_dwordx2 v[98:99], v6, s[8:11], s42 offen offset:16 sc1
    buffer_load_dwordx2 v[100:101], v6, s[8:11], s42 offen offset:128 sc1
    buffer_load_dwordx2 v[102:103], v6, s[8:11], s42 offen offset:144 sc1
    s_mov_b64 exec, 0x3fff
L_sp_7:
    s_sub_u32 s30, s30, 1
    s_cbranch_scc0 L_sp_7c
    s_mov_b32 s30, 0
    s_branch L_sp_7x
L_sp_7c:
    buffer_load_dword v119, v117, s[8:11], s60 offen sc1
    s_waitcnt vmcnt(0)
    v_cmpx_gt_u32 s[52:53], s61, v119
    s_cbranch_execnz L_sp_7
L_sp_7x:
    s_mov_b64 exec, -1
    buffer_load_dwordx4 v[16:19], v2, s[8:11], s40 offen offset:0 sc1
    buffer_load_dwordx4 v[20:23], v2, s[8:11], s40 offen offset:1024 sc1
    buffer_load_dwordx4 v[24:27], v2, s[8:11], s40 offen offset:2048 sc1
L_g2:
    s_mov_b32 s41, s40
    buffer_load_dwordx4 v[64:67], v2, s[8:11], s40 offen offset:3072 sc1
    s_add_u32 s40, s40, 4096
    buffer_load_dwordx4 v[68:71], v2, s[8:11], s40 offen offset:0 sc1
    buffer_load_dwordx4 v[72:75], v2, s[8:11], s40 offen offset:1024 sc1
    buffer_load_dwordx4 v[76:79], v2, s[8:11], s40 offen offset:2048 sc1
    buffer_load_dwordx4 v[80:83], v2, s[8:11], s40 offen offset:3072 sc1
    s_add_u32 s40, s40, 4096
    buffer_load_dwordx4 v[84:87], v2, s[8:11], s40 offen offset:0 sc1
    buffer_load_dwordx4 v[88:91], v2, s[8:11], s40 offen offset:1024 sc1
    s_waitcnt vmcnt(9)
    v_mfma_f32_32x32x16_bf16 a[224:239], v[16:19], a[0:3], 0
    buffer_load_dwordx4 v[104:107], v8, s[8:11], s49 offen offset:0 sc1
    buffer_load_dwordx4 v[108:111], v8, s[8:11], s49 offen offset:32 sc1
    v_mfma_f32_32x32x16_bf16 a[240:255], v[16:19], a[112:115], 0
    buffer_load_dwordx4 v[92:95], v2, s[8:11], s40 offen offset:2048 sc1
    s_waitcnt vmcnt(11)
    v_mfma_f32_32x32x16_bf16 a[224:239], v[20:23], a[4:7], a[224:239]
    v_mfma_f32_32x32x16_bf16 a[240:255], v[20:23], a[116:119], a[240:255]
    buffer_load_dwordx4 v[28:31], v2, s[8:11], s40 offen offset:3072 sc1
    s_add_u32 s40, s40, 4096
    s_waitcnt vmcnt(11)
    v_mfma_f32_32x32x16_bf16 a[224:239], v[24:27], a[8:11], a[224:239]
    v_mfma_f32_32x32x16_bf16 a[240:255], v[24:27], a[120:123], a[240:255]
    buffer_load_dwordx4 v[32:35], v2, s[8:11], s40 offen offset:0 sc1
    s_waitcnt vmcnt(11)
    v_mfma_f32_32x32x16_bf16 a[224:239], v[64:67], a[12:15], a[224:239]
    v_mfma_f32_32x32x16_bf16 a[240:255], v[64:67], a[124:127], a[240:255]
    buffer_load_dwordx4 v[36:39], v2, s[8:11], s40 offen offset:1024 sc1
    s_waitcnt vmcnt(11)
    v_mfma_f32_32x32x16_bf16 a[224:239], v[68:71], a[16:19], a[224:239]
    v_mfma_f32_32x32x16_bf16 a[240:255], v[68:71], a[128:131], a[240:255]
    buffer_load_dwordx4 v[40:43], v2, s[8:11], s40 offen offset:2048 sc1
    s_waitcnt vmcnt(11)
    v_mfma_f32_32x32x16_bf16 a[224:239], v[72:75], a[20:23], a[224:239]
    v_mfma_f32_32x32x16_bf16 a[240:255], v[72:75], a[132:135], a[240:255]
    buffer_load_dwordx4 v[44:47], v2, s[8:11], s40 offen offset:3072 sc1
    s_add_u32 s40, s40, 4096
    s_waitcnt vmcnt(11)
    v_mfma_f32_32x32x16_bf16 a[224:239], v[76:79], a[24:27], a[224:239]
    v_mfma_f32_32x32x16_bf16 a[240:255], v[76:79], a[136:139], a[240:255]
    buffer_load_dwordx4 v[48:51], v2, s[8:11], s40 offen offset:0 sc1
    s_waitcnt vmcnt(11)
    v_mfma_f32_32x32x16_bf16 a[224:239], v[80:83], a[28:31], a[224:239]
    v_mfma_f32_32x32x16_bf16 a[240:255], v[80:83], a[140:143], a[240:255]
    buffer_load_dwordx4 v[52:55], v2, s[8:11], s40 offen offset:1024 sc1
    s_waitcnt vmcnt(11)
    v_mfma_f32_32x32x16_bf16 a[224:239], v[84:87], a[32:35], a[224:239]
    v_mfma_f32_32x32x16_bf16 a[240:255], v[84:87], a[144:147], a[240:255]
    buffer_load_dwordx4 v[16:19], v2, s[8:11], s40 offen offset:2048 sc1
    s_waitcnt vmcnt(11)
    v_mfma_f32_32x32x16_bf16 a[224:239], v[88:91], a[36:39], a[224:239]
    v_mfma_f32_32x32x16_bf16 a[240:255], v[88:91], a[148:151], a[240:255]
    buffer_load_dwordx4 v[20:23], v2, s[8:11], s40 offen offset:3072 sc1
    s_add_u32 s40, s40, 4096
    s_waitcnt vmcnt(9)
    v_mfma_f32_32x32x16_bf16 a[224:239], v[92:95], a[40:43], a[224:239]
    v_mfma_f32_32x32x16_bf16 a[240:255], v[92:95], a[152:155], a[240:255]
    buffer_load_dwordx4 v[24:27], v2, s[8:11], s40 offen offset:0 sc1
    s_mov_b64 exec, 0x3fff
    buffer_load_dword v119, v117, s[8:11], s60 offen sc1
    s_mov_b64 exec, -1
    s_waitcnt vmcnt(10)
    v_mfma_f32_32x32x16_bf16 a[224:239], v[28:31], a[44:47], a[224:239]
    v_mfma_f32_32x32x16_bf16 a[240:255], v[28:31], a[156:159], a[240:255]
    buffer_load_dwordx4 v[64:67], v2, s[8:11], s40 offen offset:1024 sc1
    s_waitcnt vmcnt(10)
    v_mfma_f32_32x32x16_bf16 a[224:239], v[32:35], a[48:51], a[224:239]
    v_mfma_f32_32x32x16_bf16 a[240:255], v[32:35], a[160:163], a[240:255]
    buffer_load_dwordx4 v[68:71], v2, s[8:11], s40 offen offset:2048 sc1
    s_waitcnt vmcnt(10)
    v_mfma_f32_32x32x16_bf16 a[224:239], v[36:39], a[52:55], a[224:239]
    v_mfma_f32_32x32x16_bf16 a[240:255], v[36:39], a[164:167], a[240:255]
    buffer_load_dwordx4 v[72:75], v2, s[8:11], s40 offen offset:3072 sc1
    s_add_u32 s40, s40, 4096
    s_waitcnt vmcnt(10)
    v_mfma_f32_32x32x16_bf16 a[224:239], v[40:43], a[56:59], a[224:239]
    v_mfma_f32_32x32x16_bf16 a[240:255], v[40:43], a[168:171], a[240:255]
    buffer_load_dwordx4 v[76:79], v2, s[8:11], s40 offen offset:0 sc1
    s_waitcnt vmcnt(10)
    v_mfma_f32_32x32x16_bf16 a[224:239], v[44:47], a[60:63], a[224:239]
    v_mfma_f32_32x32x16_bf16 a[240:255], v[44:47], a[172:175], a[240:255]
    buffer_load_dwordx4 v[80:83], v2, s[8:11], s40 offen offset:1024 sc1
    s_waitcnt vmcnt(10)
    v_mfma_f32_32x32x16_bf16 a[224:239], v[48:51], a[64:67], a[224:239]
    v_mfma_f32_32x32x16_bf16 a[240:255], v[48:51], a[176:179], a[240:255]
    buffer_load_dwordx4 v[84:87], v2, s[8:11], s40 offen offset:2048 sc1
    s_waitcnt vmcnt(10)
    v_mfma_f32_32x32x16_bf16 a[224:239], v[52:55], a[68:71], a[224:239]
    v_mfma_f32_32x32x16_bf16 a[240:255], v[52:55], a[180:183], a[240:255]
    buffer_load_dwordx4 v[88:91], v2, s[8:11], s40 offen offset:3072 sc1
    s_add_u32 s40, s40, 4096
    s_waitcnt vmcnt(10)
    v_mfma_f32_32x32x16_bf16 a[224:239], v[16:19], a[72:75], a[224:239]
    v_mfma_f32_32x32x16_bf16 a[240:255], v[16:19], a[184:187], a[240:255]
    s_waitcnt vmcnt(7)
    s_add_u32 s61, s61, 1
    s_mov_b64 exec, 0x3fff
    v_cmpx_gt_u32 s[52:53], s61, v119
    s_cbranch_execnz L_hq_8
L_hq_8r:
    s_mov_b64 exec, -1
    s_add_u32 s40, s40, 200704
    buffer_load_dwordx4 v[28:31], v2, s[8:11], s40 offen offset:0 sc1
    s_waitcnt vmcnt(10)
    v_mfma_f32_32x32x16_bf16 a[224:239], v[20:23], a[76:79], a[224:239]
    v_mfma_f32_32x32x16_bf16 a[240:255], v[20:23], a[188:191], a[240:255]
    buffer_load_dwordx4 v[32:35], v2, s[8:11], s40 offen offset:1024 sc1
    s_waitcnt vmcnt(10)
    v_mfma_f32_32x32x16_bf16 a[224:239], v[24:27], a[80:83], a[224:239]
    v_mfma_f32_32x32x16_bf16 a[240:255], v[24:27], a[192:195], a[240:255]
    buffer_load_dwordx4 v[36:39], v2, s[8:11], s40 offen offset:2048 sc1
    s_waitcnt vmcnt(9)
    v_mfma_f32_32x32x16_bf16 a[224:239], v[64:67], a[84:87], a[224:239]
    v_lshlrev_b32 v3, 16, v3
    v_and_b32 v104, 0xffff0000, v104
    v_and_b32 v105, 0xffff0000, v105
    v_mfma_f32_32x32x16_bf16 a[240:255], v[64:67], a[196:199], a[240:255]
    buffer_load_dwordx4 v[40:43], v2, s[8:11], s40 offen offset:3072 sc1
    s_add_u32 s40, s40, 4096
    v_and_b32 v106, 0xffff0000, v106
    v_and_b32 v107, 0xffff0000, v107
    s_waitcnt vmcnt(9)
    v_mfma_f32_32x32x16_bf16 a[224:239], v[68:71], a[88:91], a[224:239]
    v_and_b32 v108, 0xffff0000, v108
    v_and_b32 v109, 0xffff0000, v109
    v_and_b32 v110, 0xffff0000, v110
    v_mfma_f32_32x32x16_bf16 a[240:255], v[68:71], a[200:203], a[240:255]
    buffer_load_dwordx4 v[44:47], v2, s[8:11], s40 offen offset:0 sc1
    v_and_b32 v111, 0xffff0000, v111
    v_rcp_f32 v104, v104
    s_waitcnt vmcnt(9)
    v_mfma_f32_32x32x16_bf16 a[224:239], v[72:75], a[92:95], a[224:239]
    v_rcp_f32 v105, v105
    v_rcp_f32 v106, v106
    v_rcp_f32 v107, v107
    v_mfma_f32_32x32x16_bf16 a[240:255], v[72:75], a[204:207], a[240:255]
    buffer_load_dwordx4 v[48:51], v2, s[8:11], s40 offen offset:1024 sc1
    v_rcp_f32 v108, v108
    v_rcp_f32 v109, v109
    s_waitcnt vmcnt(9)
    v_mfma_f32_32x32x16_bf16 a[224:239], v[76:79], a[96:99], a[224:239]
    v_rcp_f32 v110, v110
    v_rcp_f32 v111, v111
    v_mul_f32 v104, v104, v104
    v_mfma_f32_32x32x16_bf16 a[240:255], v[76:79], a[208:211], a[240:255]
    buffer_load_dwordx4 v[52:55], v2, s[8:11], s40 offen offset:2048 sc1
    v_mul_f32 v105, v105, v105
    v_mul_f32 v106, v106, v106
    s_waitcnt vmcnt(9)
    v_mfma_f32_32x32x16_bf16 a[224:239], v[80:83], a[100:103], a[224:239]
    v_mul_f32 v107, v107, v107
    v_mul_f32 v108, v108, v108
    v_mul_f32 v109, v109, v109
    v_mfma_f32_32x32x16_bf16 a[240:255], v[80:83], a[212:215], a[240:255]
    buffer_load_dwordx4 v[16:19], v2, s[8:11], s40 offen offset:3072 sc1
    s_add_u32 s40, s40, 4096
    v_mul_f32 v110, v110, v110
    v_mul_f32 v111, v111, v111
    s_waitcnt vmcnt(9)
    v_mfma_f32_32x32x16_bf16 a[224:239], v[84:87], a[104:107], a[224:239]
    v_mfma_f32_32x32x16_bf16 a[240:255], v[84:87], a[216:219], a[240:255]
    buffer_load_dwordx4 v[20:23], v2, s[8:11], s40 offen offset:0 sc1
    s_waitcnt vmcnt(9)
    v_mfma_f32_32x32x16_bf16 a[224:239], v[88:91], a[108:111], a[224:239]
    v_mfma_f32_32x32x16_bf16 a[240:255], v[88:91], a[220:223], a[240:255]
    buffer_load_dwordx4 v[24:27], v2, s[8:11], s40 offen offset:1024 sc1
    s_waitcnt vmcnt(9)
    v_mfma_f32_32x32x16_bf16 v[64:79], v[28:31], a[0:3], 0
    v_mfma_f32_32x32x16_bf16 v[80:95], v[28:31], a[112:115], 0
    buffer_load_dwordx4 v[28:31], v2, s[8:11], s40 offen offset:2048 sc1
    s_waitcnt vmcnt(9)
    v_mfma_f32_32x32x16_bf16 v[64:79], v[32:35], a[4:7], v[64:79]
    v_mfma_f32_32x32x16_bf16 v[80:95], v[32:35], a[116:119], v[80:95]
    buffer_load_dwordx4 v[32:35], v2, s[8:11], s40 offen offset:3072 sc1
    s_add_u32 s40, s40, 4096
    s_waitcnt vmcnt(9)
    v_mfma_f32_32x32x16_bf16 v[64:79], v[36:39], a[8:11], v[64:79]
    ds_write_b128 v10, a[240:243] offset:0
    ds_write_b128 v10, a[244:247] offset:1024
    ds_write_b128 v4, a[232:235] offset:0
    v_mfma_f32_32x32x16_bf16 v[80:95], v[36:39], a[120:123], v[80:95]
    buffer_load_dwordx4 v[36:39], v2, s[8:11], s40 offen offset:0 sc1
    ds_write_b128 v4, a[236:239] offset:1024
    ds_write_b128 v5, a[248:251] offset:0
    s_waitcnt vmcnt(9)
    v_mfma_f32_32x32x16_bf16 v[64:79], v[40:43], a[12:15], v[64:79]
    ds_write_b128 v5, a[252:255] offset:1024
    v_accvgpr_read_b32 v56, a224
    v_accvgpr_read_b32 v57, a225
    v_mfma_f32_32x32x16_bf16 v[80:95], v[40:43], a[124:127], v[80:95]
    buffer_load_dwordx4 v[40:43], v2, s[8:11], s40 offen offset:1024 sc1
    v_accvgpr_read_b32 v58, a226
    v_accvgpr_read_b32 v59, a227
    s_waitcnt vmcnt(9)
    v_mfma_f32_32x32x16_bf16 v[64:79], v[44:47], a[16:19], v[64:79]
    v_accvgpr_read_b32 v60, a228
    v_accvgpr_read_b32 v61, a229
    v_accvgpr_read_b32 v62, a230
    v_mfma_f32_32x32x16_bf16 v[80:95], v[44:47], a[128:131], v[80:95]
    buffer_load_dwordx4 v[44:47], v2, s[8:11], s40 offen offset:2048 sc1
    v_accvgpr_read_b32 v63, a231
    s_waitcnt lgkmcnt(0)
    s_barrier
    s_waitcnt vmcnt(9)
    v_mfma_f32_32x32x16_bf16 v[64:79], v[48:51], a[20:23], v[64:79]
    ds_read_b128 v[112:115], v11 offset:0
    ds_read_b128 v[120:123], v11 offset:1024
    s_nop 0
    v_mfma_f32_32x32x16_bf16 v[80:95], v[48:51], a[132:135], v[80:95]
    buffer_load_dwordx4 v[48:51], v2, s[8:11], s40 offen offset:3072 sc1
    s_add_u32 s40, s40, 4096
    s_nop 0
    s_nop 0
    s_waitcnt vmcnt(9)
    v_mfma_f32_32x32x16_bf16 v[64:79], v[52:55], a[24:27], v[64:79]
    s_waitcnt lgkmcnt(0)
    v_add_f32 v56, v56, v112
    v_add_f32 v57, v57, v113
    v_mfma_f32_32x32x16_bf16 v[80:95], v[52:55], a[136:139], v[80:95]
    buffer_load_dwordx4 v[52:55], v2, s[8:11], s40 offen offset:0 sc1
    v_add_f32 v58, v58, v114
    v_add_f32 v59, v59, v115
    s_waitcnt vmcnt(9)
    v_mfma_f32_32x32x16_bf16 v[64:79], v[16:19], a[28:31], v[64:79]
    v_add_f32 v60, v60, v120
    v_add_f32 v61, v61, v121
    v_add_f32 v62, v62, v122
    v_mfma_f32_32x32x16_bf16 v[80:95], v[16:19], a[140:143], v[80:95]
    buffer_load_dwordx4 v[16:19], v2, s[8:11], s40 offen offset:1024 sc1
    v_add_f32 v63, v63, v123
    ds_read_b128 v[112:115], v11 offset:2048
    s_waitcnt vmcnt(9)
    v_mfma_f32_32x32x16_bf16 v[64:79], v[20:23], a[32:35], v[64:79]
    ds_read_b128 v[120:123], v11 offset:3072
    s_nop 0
    s_nop 0
    v_mfma_f32_32x32x16_bf16 v[80:95], v[20:23], a[144:147], v[80:95]
    buffer_load_dwordx4 v[20:23], v2, s[8:11], s40 offen offset:2048 sc1
    s_nop 0
    s_waitcnt lgkmcnt(0)
    s_waitcnt vmcnt(9)
    v_mfma_f32_32x32x16_bf16 v[64:79], v[24:27], a[36:39], v[64:79]
    v_add_f32 v56, v56, v112
    v_add_f32 v57, v57, v113
    v_add_f32 v58, v58, v114
    v_mfma_f32_32x32x16_bf16 v[80:95], v[24:27], a[148:151], v[80:95]
    buffer_load_dwordx4 v[24:27], v2, s[8:11], s40 offen offset:3072 sc1
    s_add_u32 s40, s40, 4096
    v_add_f32 v59, v59, v115
    v_add_f32 v60, v60, v120
    s_waitcnt vmcnt(9)
    v_mfma_f32_32x32x16_bf16 v[64:79], v[28:31], a[40:43], v[64:79]
    v_add_f32 v61, v61, v121
    v_add_f32 v62, v62, v122
    v_add_f32 v63, v63, v123
    v_mfma_f32_32x32x16_bf16 v[80:95], v[28:31], a[152:155], v[80:95]
    buffer_load_dwordx4 v[28:31], v2, s[8:11], s40 offen offset:0 sc1
    ds_read_b128 v[112:115], v11 offset:4096
    ds_read_b128 v[120:123], v11 offset:5120
    s_waitcnt vmcnt(9)
    v_mfma_f32_32x32x16_bf16 v[64:79], v[32:35], a[44:47], v[64:79]
    s_nop 0
    s_nop 0
    s_nop 0
    v_mfma_f32_32x32x16_bf16 v[80:95], v[32:35], a[156:159], v[80:95]
    buffer_load_dwordx4 v[32:35], v2, s[8:11], s40 offen offset:1024 sc1
    s_waitcnt lgkmcnt(0)
    v_add_f32 v56, v56, v112
    s_waitcnt vmcnt(9)
    v_mfma_f32_32x32x16_bf16 v[64:79], v[36:39], a[48:51], v[64:79]
    v_add_f32 v57, v57, v113
    v_add_f32 v58, v58, v114
    v_add_f32 v59, v59, v115
    v_mfma_f32_32x32x16_bf16 v[80:95], v[36:39], a[160:163], v[80:95]
    buffer_load_dwordx4 v[36:39], v2, s[8:11], s40 offen offset:2048 sc1
    v_add_f32 v60, v60, v120
    v_add_f32 v61, v61, v121
    s_waitcnt vmcnt(9)
    v_mfma_f32_32x32x16_bf16 v[64:79], v[40:43], a[52:55], v[64:79]
    v_add_f32 v62, v62, v122
    v_add_f32 v63, v63, v123
    v_fma_f32 v56, v56, v104, v3
    v_mfma_f32_32x32x16_bf16 v[80:95], v[40:43], a[164:167], v[80:95]
    buffer_load_dwordx4 v[40:43], v2, s[8:11], s40 offen offset:3072 sc1
    s_add_u32 s40, s40, 4096
    v_fma_f32 v57, v57, v105, v3
    v_lshlrev_b32 v112, 16, v96
    s_waitcnt vmcnt(9)
    v_mfma_f32_32x32x16_bf16 v[64:79], v[44:47], a[56:59], v[64:79]
    v_and_b32 v113, 0xffff0000, v96
    v_add_f32 v56, v56, v112
    v_add_f32 v57, v57, v113
    v_mfma_f32_32x32x16_bf16 v[80:95], v[44:47], a[168:171], v[80:95]
    buffer_load_dwordx4 v[44:47], v2, s[8:11], s40 offen offset:0 sc1
    v_cvt_pk_bf16_f32 v96, v56, v57
    v_fma_f32 v58, v58, v106, v3
    s_waitcnt vmcnt(9)
    v_mfma_f32_32x32x16_bf16 v[64:79], v[48:51], a[60:63], v[64:79]
    v_fma_f32 v59, v59, v107, v3
    v_lshlrev_b32 v112, 16, v97
    v_and_b32 v113, 0xffff0000, v97
    v_mfma_f32_32x32x16_bf16 v[80:95], v[48:51], a[172:175], v[80:95]
    buffer_load_dwordx4 v[48:51], v2, s[8:11], s40 offen offset:1024 sc1
    v_add_f32 v58, v58, v112
    v_add_f32 v59, v59, v113
    s_waitcnt vmcnt(9)
    v_mfma_f32_32x32x16_bf16 v[64:79], v[52:55], a[64:67], v[64:79]
    v_cvt_pk_bf16_f32 v97, v58, v59
    v_fma_f32 v60, v60, v108, v3
    v_fma_f32 v61, v61, v109, v3
    v_mfma_f32_32x32x16_bf16 v[80:95], v[52:55], a[176:179], v[80:95]
    buffer_load_dwordx4 v[52:55], v2, s[8:11], s40 offen offset:2048 sc1
    v_lshlrev_b32 v112, 16, v98
    v_and_b32 v113, 0xffff0000, v98
    s_waitcnt vmcnt(9)
    v_mfma_f32_32x32x16_bf16 v[64:79], v[16:19], a[68:71], v[64:79]
    v_add_f32 v60, v60, v112
    v_add_f32 v61, v61, v113
    v_cvt_pk_bf16_f32 v98, v60, v61
    v_mfma_f32_32x32x16_bf16 v[80:95], v[16:19], a[180:183], v[80:95]
    buffer_load_dwordx4 v[16:19], v2, s[8:11], s40 offen offset:3072 sc1
    s_add_u32 s40, s40, 4096
    v_fma_f32 v62, v62, v110, v3
    v_fma_f32 v63, v63, v111, v3
    s_waitcnt vmcnt(9)
    v_mfma_f32_32x32x16_bf16 v[64:79], v[20:23], a[72:75], v[64:79]
    v_lshlrev_b32 v112, 16, v99
    v_and_b32 v113, 0xffff0000, v99
    v_add_f32 v62, v62, v112
    v_mfma_f32_32x32x16_bf16 v[80:95], v[20:23], a[184:187], v[80:95]
    v_add_f32 v63, v63, v113
    v_cvt_pk_bf16_f32 v99, v62, v63
    s_waitcnt vmcnt(8)
    v_mfma_f32_32x32x16_bf16 v[64:79], v[24:27], a[76:79], v[64:79]
    s_nop 1
    v_permlane32_swap_b32 v96, v98
    v_permlane32_swap_b32 v97, v99
    ds_write_b128 v12, v[96:99] offset:0
    buffer_load_dwordx4 v[104:107], v8, s[8:11], s49 offen offset:256 sc1
    v_mfma_f32_32x32x16_bf16 v[80:95], v[24:27], a[188:191], v[80:95]
    buffer_load_dwordx4 v[108:111], v8, s[8:11], s49 offen offset:288 sc1
    s_waitcnt lgkmcnt(0)
    s_barrier
    s_waitcnt vmcnt(9)
    v_mfma_f32_32x32x16_bf16 v[64:79], v[28:31], a[80:83], v[64:79]
    ds_read_b64_tr_b16 v[56:57], v13 offset:0
    ds_read_b64_tr_b16 v[58:59], v13 offset:576
    ds_read_b64_tr_b16 v[60:61], v13 offset:1152
    v_mfma_f32_32x32x16_bf16 v[80:95], v[28:31], a[192:195], v[80:95]
    ds_read_b64_tr_b16 v[62:63], v13 offset:1728
    s_waitcnt vmcnt(8)
    v_mfma_f32_32x32x16_bf16 v[64:79], v[32:35], a[84:87], v[64:79]
    v_mfma_f32_32x32x16_bf16 v[80:95], v[32:35], a[196:199], v[80:95]
    s_waitcnt vmcnt(7)
    v_mfma_f32_32x32x16_bf16 v[64:79], v[36:39], a[88:91], v[64:79]
    s_cmp_lg_u32 s29, 0
    s_cbranch_scc1 L_pt_10
    ds_read_b128 v[96:99], v7 offset:0
    s_add_u32 s55, s54, 0
    v_mov_b32 v112, 0
    v_mov_b32 v113, 0
    s_waitcnt lgkmcnt(0)
    buffer_store_dwordx4 v[96:99], v116, s[8:11], s55 offen sc1
    v_dot2_f32_bf16 v112, v56, s59, v112
    v_dot2_f32_bf16 v113, v56, v56, v113
    v_dot2_f32_bf16 v112, v57, s59, v112
    v_dot2_f32_bf16 v113, v57, v57, v113
    v_dot2_f32_bf16 v112, v58, s59, v112
    v_dot2_f32_bf16 v113, v58, v58, v113
    v_dot2_f32_bf16 v112, v59, s59, v112
    v_dot2_f32_bf16 v113, v59, v59, v113
    v_dot2_f32_bf16 v112, v60, s59, v112
    v_dot2_f32_bf16 v113, v60, v60, v113
    v_dot2_f32_bf16 v112, v61, s59, v112
    v_dot2_f32_bf16 v113, v61, v61, v113
    v_dot2_f32_bf16 v112, v62, s59, v112
    v_dot2_f32_bf16 v113, v62, v62, v113
    v_dot2_f32_bf16 v112, v63, s59, v112
    v_dot2_f32_bf16 v113, v63, v63, v113
    s_nop 2
    v_mov_b32 v114, v112
    v_mov_b32 v115, v113
    s_nop 1
    v_permlane32_swap_b32 v112, v114
    v_permlane32_swap_b32 v113, v115
    s_nop 1
    v_add_f32 v112, v112, v114
    v_add_f32 v113, v113, v115
    v_mov_b32 v114, v112
    v_mov_b32 v115, v113
    s_nop 1
    v_permlane16_swap_b32 v112, v114
    v_permlane16_swap_b32 v113, v115
    s_nop 1
    v_add_f32 v112, v112, v114
    v_add_f32 v113, v113, v115
    v_and_b32 v114, 1, v15
    v_cmp_eq_u32 s[52:53], 1, v114
    v_lshlrev_b32 v115, 2, v14
    v_lshl_add_u32 v115, v114, 13, v115
    v_cndmask_b32 v112, v112, v113, s[52:53]
    s_mov_b32 s55, 0x1802000
    s_cmp_lt_u32 s3, 2
    s_cselect_b32 exec_lo, -1, 0
    s_mov_b32 exec_hi, 0
    buffer_atomic_add_f32 v112, v115, s[8:11], s55 offen offset:0 sc1
    s_mov_b64 exec, -1
    s_branch L_pt_11
L_pt_10:
    v_lshlrev_b32 v112, 10, v14
    v_lshl_add_u32 v112, v15, 5, v112
    s_add_u32 s55, s56, 0
    s_cmp_lt_u32 s3, 2
    s_cselect_b64 exec, -1, 0
    s_waitcnt lgkmcnt(0)
    buffer_store_dwordx4 v[56:59], v112, s[16:19], s55 offen nt
    buffer_store_dwordx4 v[60:63], v112, s[16:19], s55 offen offset:16 nt
    s_mov_b64 exec, -1
L_pt_11:
    v_mfma_f32_32x32x16_bf16 v[80:95], v[36:39], a[200:203], v[80:95]
    s_waitcnt vmcnt(2)
    s_waitcnt vmcnt(8)
    v_mfma_f32_32x32x16_bf16 v[64:79], v[40:43], a[92:95], v[64:79]
    v_and_b32 v104, 0xffff0000, v104
    v_and_b32 v105, 0xffff0000, v105
    v_and_b32 v106, 0xffff0000, v106
    v_mfma_f32_32x32x16_bf16 v[80:95], v[40:43], a[204:207], v[80:95]
    v_and_b32 v107, 0xffff0000, v107
    v_and_b32 v108, 0xffff0000, v108
    s_waitcnt vmcnt(7)
    v_mfma_f32_32x32x16_bf16 v[64:79], v[44:47], a[96:99], v[64:79]
    v_and_b32 v109, 0xffff0000, v109
    v_and_b32 v110, 0xffff0000, v110
    v_and_b32 v111, 0xffff0000, v111
    v_mfma_f32_32x32x16_bf16 v[80:95], v[44:47], a[208:211], v[80:95]
    v_rcp_f32 v104, v104
    v_rcp_f32 v105, v105
    s_waitcnt vmcnt(6)
    v_mfma_f32_32x32x16_bf16 v[64:79], v[48:51], a[100:103], v[64:79]
    v_rcp_f32 v106, v106
    v_rcp_f32 v107, v107
    v_rcp_f32 v108, v108
    v_mfma_f32_32x32x16_bf16 v[80:95], v[48:51], a[212:215], v[80:95]
    v_rcp_f32 v109, v109
    v_rcp_f32 v110, v110
    s_waitcnt vmcnt(5)
    v_mfma_f32_32x32x16_bf16 v[64:79], v[52:55], a[104:107], v[64:79]
    v_rcp_f32 v111, v111
    v_mul_f32 v104, v104, v104
    v_mul_f32 v105, v105, v105
    v_mfma_f32_32x32x16_bf16 v[80:95], v[52:55], a[216:219], v[80:95]
    v_mul_f32 v106, v106, v106
    v_mul_f32 v107, v107, v107
    s_waitcnt vmcnt(4)
    v_mfma_f32_32x32x16_bf16 v[64:79], v[16:19], a[108:111], v[64:79]
    v_mul_f32 v108, v108, v108
    v_mul_f32 v109, v109, v109
    v_mul_f32 v110, v110, v110
    v_mfma_f32_32x32x16_bf16 v[80:95], v[16:19], a[220:223], v[80:95]
    v_mul_f32 v111, v111, v111
    s_nop 7
    s_nop 3
    ds_write_b128 v10, v[80:83] offset:24576
    ds_write_b128 v10, v[84:87] offset:25600
    ds_write_b128 v4, v[72:75] offset:24576
    ds_write_b128 v4, v[76:79] offset:25600
    ds_write_b128 v5, v[88:91] offset:24576
    ds_write_b128 v5, v[92:95] offset:25600
    s_waitcnt lgkmcnt(0)
    s_barrier
    ds_read_b128 v[16:19], v11 offset:24576
    ds_read_b128 v[20:23], v11 offset:25600
    ds_read_b128 v[24:27], v11 offset:26624
    ds_read_b128 v[28:31], v11 offset:27648
    ds_read_b128 v[32:35], v11 offset:28672
    ds_read_b128 v[36:39], v11 offset:29696
    s_waitcnt lgkmcnt(0)
    v_pk_add_f32 v[64:65], v[64:65], v[16:17]
    v_pk_add_f32 v[66:67], v[66:67], v[18:19]
    v_pk_add_f32 v[68:69], v[68:69], v[20:21]
    v_pk_add_f32 v[70:71], v[70:71], v[22:23]
    v_pk_add_f32 v[64:65], v[64:65], v[24:25]
    v_pk_add_f32 v[66:67], v[66:67], v[26:27]
    v_pk_add_f32 v[68:69], v[68:69], v[28:29]
    v_pk_add_f32 v[70:71], v[70:71], v[30:31]
    v_pk_add_f32 v[64:65], v[64:65], v[32:33]
    v_pk_add_f32 v[66:67], v[66:67], v[34:35]
    v_pk_add_f32 v[68:69], v[68:69], v[36:37]
    v_pk_add_f32 v[70:71], v[70:71], v[38:39]
    v_pk_fma_f32 v[64:65], v[64:65], v[104:105], v[2:3] op_sel:[0,0,1] op_sel_hi:[1,1,1]
    v_lshlrev_b32 v112, 16, v100
    v_and_b32 v113, 0xffff0000, v100
    v_pk_add_f32 v[64:65], v[64:65], v[112:113]
    v_cvt_pk_bf16_f32 v100, v64, v65
    v_pk_fma_f32 v[66:67], v[66:67], v[106:107], v[2:3] op_sel:[0,0,1] op_sel_hi:[1,1,1]
    v_lshlrev_b32 v112, 16, v101
    v_and_b32 v113, 0xffff0000, v101
    v_pk_add_f32 v[66:67], v[66:67], v[112:113]
    v_cvt_pk_bf16_f32 v101, v66, v67
    v_pk_fma_f32 v[68:69], v[68:69], v[108:109], v[2:3] op_sel:[0,0,1] op_sel_hi:[1,1,1]
    v_lshlrev_b32 v112, 16, v102
    v_and_b32 v113, 0xffff0000, v102
    v_pk_add_f32 v[68:69], v[68:69], v[112:113]
    v_cvt_pk_bf16_f32 v102, v68, v69
    v_pk_fma_f32 v[70:71], v[70:71], v[110:111], v[2:3] op_sel:[0,0,1] op_sel_hi:[1,1,1]
    v_lshlrev_b32 v112, 16, v103
    v_and_b32 v113, 0xffff0000, v103
    v_pk_add_f32 v[70:71], v[70:71], v[112:113]
    v_cvt_pk_bf16_f32 v103, v70, v71
    s_nop 1
    v_permlane32_swap_b32 v100, v102
    v_permlane32_swap_b32 v101, v103
    ds_write_b128 v12, v[100:103] offset:64
    s_waitcnt lgkmcnt(0)
    s_barrier
    ds_read_b64_tr_b16 v[40:41], v13 offset:64
    ds_read_b64_tr_b16 v[42:43], v13 offset:640
    ds_read_b64_tr_b16 v[44:45], v13 offset:1216
    ds_read_b64_tr_b16 v[46:47], v13 offset:1792
    s_cmp_lg_u32 s29, 0
    s_cbranch_scc1 L_pt_12
    ds_read_b128 v[100:103], v7 offset:64
    s_add_u32 s55, s54, 65536
    v_mov_b32 v48, 0
    v_mov_b32 v49, 0
    s_waitcnt lgkmcnt(0)
    buffer_store_dwordx4 v[100:103], v116, s[8:11], s55 offen sc1
    v_dot2_f32_bf16 v48, v40, s59, v48
    v_dot2_f32_bf16 v49, v40, v40, v49
    v_dot2_f32_bf16 v48, v41, s59, v48
    v_dot2_f32_bf16 v49, v41, v41, v49
    v_dot2_f32_bf16 v48, v42, s59, v48
    v_dot2_f32_bf16 v49, v42, v42, v49
    v_dot2_f32_bf16 v48, v43, s59, v48
    v_dot2_f32_bf16 v49, v43, v43, v49
    v_dot2_f32_bf16 v48, v44, s59, v48
    v_dot2_f32_bf16 v49, v44, v44, v49
    v_dot2_f32_bf16 v48, v45, s59, v48
    v_dot2_f32_bf16 v49, v45, v45, v49
    v_dot2_f32_bf16 v48, v46, s59, v48
    v_dot2_f32_bf16 v49, v46, v46, v49
    v_dot2_f32_bf16 v48, v47, s59, v48
    v_dot2_f32_bf16 v49, v47, v47, v49
    s_nop 2
    v_mov_b32 v50, v48
    v_mov_b32 v51, v49
    s_nop 1
    v_permlane32_swap_b32 v48, v50
    v_permlane32_swap_b32 v49, v51
    s_nop 1
    v_add_f32 v48, v48, v50
    v_add_f32 v49, v49, v51
    v_mov_b32 v50, v48
    v_mov_b32 v51, v49
    s_nop 1
    v_permlane16_swap_b32 v48, v50
    v_permlane16_swap_b32 v49, v51
    s_nop 1
    v_add_f32 v48, v48, v50
    v_add_f32 v49, v49, v51
    v_and_b32 v50, 1, v15
    v_cmp_eq_u32 s[52:53], 1, v50
    v_lshlrev_b32 v51, 2, v14
    v_lshl_add_u32 v51, v50, 13, v51
    v_cndmask_b32 v48, v48, v49, s[52:53]
    s_mov_b32 s55, 0x1802000
    s_cmp_lt_u32 s3, 2
    s_cselect_b32 exec_lo, -1, 0
    s_mov_b32 exec_hi, 0
    buffer_atomic_add_f32 v48, v51, s[8:11], s55 offen offset:256 sc1
    s_mov_b64 exec, -1
    s_branch L_pt_13
L_pt_12:
    v_lshlrev_b32 v48, 10, v14
    v_lshl_add_u32 v48, v15, 5, v48
    s_add_u32 s55, s56, 65536
    s_cmp_lt_u32 s3, 2
    s_cselect_b64 exec, -1, 0
    s_waitcnt lgkmcnt(0)
    buffer_store_dwordx4 v[40:43], v48, s[16:19], s55 offen nt
    buffer_store_dwordx4 v[44:47], v48, s[16:19], s55 offen offset:16 nt
    s_mov_b64 exec, -1
L_pt_13:
    s_cmp_lg_u32 s29, 0
    s_cbranch_scc1 L_done
    s_waitcnt vmcnt(0)
    s_barrier
    s_add_u32 s39, s39, 1
    s_mul_i32 s52, s2, 64
    s_add_u32 s52, s52, 0x180a000
    v_mov_b32 v118, s39
    v_mov_b32 v119, 0
    s_cmp_eq_u32 s3, 0
    s_cselect_b64 exec, 1, 0
    buffer_store_dword v118, v119, s[8:11], s52 offen sc1
    s_mov_b64 exec, -1
    v_lshlrev_b32 v2, 4, v0
    v_add_u32 v3, 153600, v2
    v_add_u32 v2, 9248, v2
    ds_read_b64 v[10:11], v3 offset:8
    ds_read_b128 v[12:15], v3 offset:16
    ds_read_b64 v[16:17], v3 offset:4120
    ds_read_b128 v[18:21], v3 offset:4128
    v_mov_b32 v22, 0
    v_mov_b32 v23, 0
    v_mov_b32 v24, 0
    v_mov_b32 v25, 0
    v_bfe_u32 v4, v0, 5, 1
    v_mul_u32_u24 v4, 4608, v4
    v_and_b32 v5, 31, v0
    v_lshl_add_u32 v4, v5, 4, v4
    v_add_u32 v4, 0, v4
    ds_write_b128 v4, v[22:25]
    v_bfe_u32 v4, v0, 3, 1
    v_mul_u32_u24 v4, 16640, v4
    v_bfe_u32 v5, v0, 1, 2
    v_mul_u32_u24 v5, 4160, v5
    v_add_u32 v4, v4, v5
    v_and_b32 v5, 1, v0
    v_lshl_add_u32 v4, v5, 4, v4
    v_add_u32 v4, 9216, v4
    ds_write_b128 v4, v[22:25]
    s_waitcnt lgkmcnt(2)
    ds_write_b128 v2, v[12:15] offset:0
    v_alignbit_b32 v26, v11, v10, 16
    v_alignbit_b32 v27, v12, v11, 16
    v_alignbit_b32 v28, v13, v12, 16
    v_alignbit_b32 v29, v14, v13, 16
    ds_write_b128 v2, v[26:29] offset:12480
    v_alignbit_b32 v30, v12, v11, 16
    v_alignbit_b32 v31, v13, v12, 16
    v_alignbit_b32 v32, v14, v13, 16
    v_alignbit_b32 v33, v15, v14, 16
    ds_write_b128 v2, v[30:33] offset:4160
    v_mov_b32 v34, v11
    v_mov_b32 v35, v12
    v_mov_b32 v36, v13
    v_mov_b32 v37, v14
    ds_write_b128 v2, v[34:37] offset:8320
    ds_write_b128 v2, v[18:21] offset:16640
    v_alignbit_b32 v38, v17, v16, 16
    v_alignbit_b32 v39, v18, v17, 16
    v_alignbit_b32 v40, v19, v18, 16
    v_alignbit_b32 v41, v20, v19, 16
    ds_write_b128 v2, v[38:41] offset:29120
    v_alignbit_b32 v42, v18, v17, 16
    v_alignbit_b32 v43, v19, v18, 16
    v_alignbit_b32 v44, v20, v19, 16
    v_alignbit_b32 v45, v21, v20, 16
    ds_write_b128 v2, v[42:45] offset:20800
    v_mov_b32 v46, v17
    v_mov_b32 v47, v18
    v_mov_b32 v48, v19
    v_mov_b32 v49, v20
    ds_write_b128 v2, v[46:49] offset:24960
    s_mov_b32 s29, 1
    s_mov_b32 s36, 0x600000
    s_mov_b32 s37, 0x1000000
    s_mov_b32 s38, 0x1808000
    v_and_b32 v6, 15, v0
    v_bfe_u32 v7, v0, 4, 2
    s_lshr_b32 s43, s3, 1
    s_and_b32 s44, s3, 1
    v_lshrrev_b32 v8, 2, v6
    v_mul_u32_u24 v12, 4160, v8
    v_and_b32 v8, 3, v0
    v_lshl_add_u32 v12, v8, 3, v12
    v_lshlrev_b32 v8, 4, v7
    v_sub_u32 v12, v12, v8
    s_mul_i32 s45, s43, 16640
    s_lshl_b32 s46, s44, 8
    s_add_u32 s45, s45, s46
    s_add_u32 s45, s45, 9272
    v_add_u32 v12, s45, v12
    v_lshlrev_b32 v13, 5, v6
    v_lshl_add_u32 v11, v7, 3, v13
    v_lshl_add_u32 v13, v7, 4, v13
    s_mul_i32 s45, s43, 4608
    s_sub_u32 s47, s45, s46
    s_add_u32 s47, s47, 288
    v_add_u32 v13, s47, v13
    s_lshl_b32 s47, s3, 12
    s_add_u32 s47, s47, 42496
    v_add_u32 v14, s47, v116
    s_xor_b32 s47, s3, 1
    s_lshl_b32 s47, s47, 12
    s_add_u32 s47, s47, 42496
    v_add_u32 v15, s47, v116
    v_and_b32 v8, 1, v7
    v_lshlrev_b32 v10, 9, v8
    v_lshl_add_u32 v10, v6, 5, v10
    v_lshrrev_b32 v8, 1, v7
    v_lshl_add_u32 v10, v8, 4, v10
    s_lshl_b32 s48, s2, 1
    s_add_u32 s48, s48, s43
    s_lshl_b32 s48, s48, 12
    s_lshl_b32 s46, s44, 11
    s_add_u32 s48, s48, s46
    s_add_u32 s48, s48, s36
    s_add_u32 s45, s45, s46
    s_add_u32 s45, s45, 512
    v_add_u32 v9, s45, v11
    s_lshl_b32 s45, s43, 12
    s_add_u32 s45, s45, s46
    s_add_u32 s45, s45, 58880
    v_add_u32 v11, s45, v11
    s_lshl_b32 s49, s28, 16
    s_and_b32 s45, s28, 0xffff0000
    s_cmp_eq_u32 s43, 0
    s_cselect_b32 s49, s49, s45
    s_waitcnt lgkmcnt(0)
    v_mul_u32_u24 v118, 64, v0
    s_mov_b32 s54, 0x180a000
L_sp_14:
    s_sub_u32 s30, s30, 1
    s_cbranch_scc0 L_sp_14c
    s_mov_b32 s30, 0
    s_branch L_sp_14x
L_sp_14c:
    buffer_load_dword v119, v118, s[8:11], s54 offen sc1
    s_waitcnt vmcnt(0)
    v_cmpx_gt_u32 s[52:53], s39, v119
    s_cbranch_execnz L_sp_14
L_sp_14x:
    s_mov_b64 exec, -1
    s_barrier
    s_branch L_layer
L_done:
L_end:
    s_endpgm
L_gr0:
    v_add_u32 v50, 0, v0
    v_add_u32 v51, 256, v0
    v_cvt_f32_u32 v50, v50
    v_cvt_f32_u32 v51, v51
    v_cvt_pk_bf16_f32 v50, v50, v51
    v_and_b32 v51, 0xffff0000, v50
    v_lshlrev_b32 v50, 16, v50
    v_mul_f32 v50, v122, v50
    v_mul_f32 v51, v122, v51
    v_mul_f32 v50, 0.5, v50
    v_mul_f32 v51, 0.5, v51
    v_exp_f32 v50, v50
    v_exp_f32 v51, v51
    s_nop 0
    v_pk_mul_f32 v[64:65], v[64:65], v[50:51]
    v_pk_mul_f32 v[64:65], v[64:65], v[50:51]
    v_add_u32 v50, 512, v0
    v_add_u32 v51, 768, v0
    v_cvt_f32_u32 v50, v50
    v_cvt_f32_u32 v51, v51
    v_cvt_pk_bf16_f32 v50, v50, v51
    v_and_b32 v51, 0xffff0000, v50
    v_lshlrev_b32 v50, 16, v50
    v_mul_f32 v50, v122, v50
    v_mul_f32 v51, v122, v51
    v_mul_f32 v50, 0.5, v50
    v_mul_f32 v51, 0.5, v51
    v_exp_f32 v50, v50
    v_exp_f32 v51, v51
    s_nop 0
    v_pk_mul_f32 v[66:67], v[66:67], v[50:51]
    v_pk_mul_f32 v[66:67], v[66:67], v[50:51]
    v_add_u32 v50, 1024, v0
    v_add_u32 v51, 1280, v0
    v_cvt_f32_u32 v50, v50
    v_cvt_f32_u32 v51, v51
    v_cvt_pk_bf16_f32 v50, v50, v51
    v_and_b32 v51, 0xffff0000, v50
    v_lshlrev_b32 v50, 16, v50
    v_mul_f32 v50, v122, v50
    v_mul_f32 v51, v122, v51
    v_mul_f32 v50, 0.5, v50
    v_mul_f32 v51, 0.5, v51
    v_exp_f32 v50, v50
    v_exp_f32 v51, v51
    s_nop 0
    v_pk_mul_f32 v[68:69], v[68:69], v[50:51]
    v_pk_mul_f32 v[68:69], v[68:69], v[50:51]
    v_add_u32 v50, 1536, v0
    v_add_u32 v51, 1792, v0
    v_cvt_f32_u32 v50, v50
    v_cvt_f32_u32 v51, v51
    v_cvt_pk_bf16_f32 v50, v50, v51
    v_and_b32 v51, 0xffff0000, v50
    v_lshlrev_b32 v50, 16, v50
    v_mul_f32 v50, v122, v50
    v_mul_f32 v51, v122, v51
    v_mul_f32 v50, 0.5, v50
    v_mul_f32 v51, 0.5, v51
    v_exp_f32 v50, v50
    v_exp_f32 v51, v51
    s_nop 0
    v_pk_mul_f32 v[70:71], v[70:71], v[50:51]
    v_pk_mul_f32 v[70:71], v[70:71], v[50:51]
    s_branch L_gr0r
L_gr1:
    v_add_u32 v50, 0, v0
    v_add_u32 v51, 256, v0
    v_cvt_f32_u32 v50, v50
    v_cvt_f32_u32 v51, v51
    v_cvt_pk_bf16_f32 v50, v50, v51
    v_and_b32 v51, 0xffff0000, v50
    v_lshlrev_b32 v50, 16, v50
    v_mul_f32 v50, v123, v50
    v_mul_f32 v51, v123, v51
    v_mul_f32 v50, 0.5, v50
    v_mul_f32 v51, 0.5, v51
    v_exp_f32 v50, v50
    v_exp_f32 v51, v51
    s_nop 0
    v_pk_mul_f32 v[80:81], v[80:81], v[50:51]
    v_pk_mul_f32 v[80:81], v[80:81], v[50:51]
    v_add_u32 v50, 512, v0
    v_add_u32 v51, 768, v0
    v_cvt_f32_u32 v50, v50
    v_cvt_f32_u32 v51, v51
    v_cvt_pk_bf16_f32 v50, v50, v51
    v_and_b32 v51, 0xffff0000, v50
    v_lshlrev_b32 v50, 16, v50
    v_mul_f32 v50, v123, v50
    v_mul_f32 v51, v123, v51
    v_mul_f32 v50, 0.5, v50
    v_mul_f32 v51, 0.5, v51
    v_exp_f32 v50, v50
    v_exp_f32 v51, v51
    s_nop 0
    v_pk_mul_f32 v[82:83], v[82:83], v[50:51]
    v_pk_mul_f32 v[82:83], v[82:83], v[50:51]
    v_add_u32 v50, 1024, v0
    v_add_u32 v51, 1280, v0
    v_cvt_f32_u32 v50, v50
    v_cvt_f32_u32 v51, v51
    v_cvt_pk_bf16_f32 v50, v50, v51
    v_and_b32 v51, 0xffff0000, v50
    v_lshlrev_b32 v50, 16, v50
    v_mul_f32 v50, v123, v50
    v_mul_f32 v51, v123, v51
    v_mul_f32 v50, 0.5, v50
    v_mul_f32 v51, 0.5, v51
    v_exp_f32 v50, v50
    v_exp_f32 v51, v51
    s_nop 0
    v_pk_mul_f32 v[84:85], v[84:85], v[50:51]
    v_pk_mul_f32 v[84:85], v[84:85], v[50:51]
    v_add_u32 v50, 1536, v0
    v_add_u32 v51, 1792, v0
    v_cvt_f32_u32 v50, v50
    v_cvt_f32_u32 v51, v51
    v_cvt_pk_bf16_f32 v50, v50, v51
    v_and_b32 v51, 0xffff0000, v50
    v_lshlrev_b32 v50, 16, v50
    v_mul_f32 v50, v123, v50
    v_mul_f32 v51, v123, v51
    v_mul_f32 v50, 0.5, v50
    v_mul_f32 v51, 0.5, v51
    v_exp_f32 v50, v50
    v_exp_f32 v51, v51
    s_nop 0
    v_pk_mul_f32 v[86:87], v[86:87], v[50:51]
    v_pk_mul_f32 v[86:87], v[86:87], v[50:51]
    s_branch L_gr1r
L_lp_2:
    s_sub_u32 s30, s30, 1
    s_cbranch_scc0 L_lp_2c
    s_mov_b32 s30, 0
    s_branch L_lk_3
L_lp_2c:
    buffer_load_dword v112, v15, s[8:11], s48 offen offset:0 sc1
    buffer_load_dword v113, v15, s[8:11], s48 offen offset:128 sc1
    s_waitcnt vmcnt(0)
    v_min_u32 v8, v112, v113
    v_cmp_eq_u32 s[52:53], 0, v8
    s_nop 0
    s_cmp_lg_u64 s[52:53], 0
    s_cbranch_scc1 L_lp_2
    s_branch L_lk_3
L_lp_4:
    s_sub_u32 s30, s30, 1
    s_cbranch_scc0 L_lp_4c
    s_mov_b32 s30, 0
    s_branch L_lk_5
L_lp_4c:
    buffer_load_dword v114, v15, s[8:11], s48 offen offset:256 sc1
    buffer_load_dword v115, v15, s[8:11], s48 offen offset:384 sc1
    s_waitcnt vmcnt(0)
    v_min_u32 v8, v114, v115
    v_cmp_eq_u32 s[52:53], 0, v8
    s_nop 0
    s_cmp_lg_u64 s[52:53], 0
    s_cbranch_scc1 L_lp_4
    s_branch L_lk_5
L_hq_8:
L_sp_9:
    s_sub_u32 s30, s30, 1
    s_cbranch_scc0 L_sp_9c
    s_mov_b32 s30, 0
    s_branch L_sp_9x
L_sp_9c:
    buffer_load_dword v119, v117, s[8:11], s60 offen sc1
    s_waitcnt vmcnt(0)
    v_cmpx_gt_u32 s[52:53], s61, v119
    s_cbranch_execnz L_sp_9
L_sp_9x:
    s_mov_b64 exec, -1
    s_branch L_hq_8r
L_code_end:
.section .rodata,"a"
.p2align 6
.amdhsa_kernel interleave_layers__ssm_conv_s4__dense_activation_squared_relu__prompt_kernel
  .amdhsa_next_free_vgpr 512
  .amdhsa_next_free_sgpr 102
  .amdhsa_accum_offset 256
  .amdhsa_group_segment_fixed_size 0
  .amdhsa_kernarg_size 136
  .amdhsa_user_sgpr_count 2
  .amdhsa_user_sgpr_kernarg_segment_ptr 1
  .amdhsa_system_sgpr_workgroup_id_x 1
  .amdhsa_float_denorm_mode_32 3
.end_amdhsa_kernel
```
